```python
import torch

def _softmax(x, axis=-1):
    return torch.softmax(x, dim=axis)
def _gelu(x):
    return torch.nn.functional.gelu(x, approximate="tanh")
def _silu(x):
    return torch.nn.functional.silu(x)
def _sigmoid(x):
    return torch.sigmoid(x)
def _layernorm(x, axis=-1, eps=1e-5):
    m = x.mean(dim=axis, keepdim=True)
    v = x.var(dim=axis, keepdim=True, unbiased=False)
    return (x - m) / torch.sqrt(v + eps)
def _scatter_add(tgt, idx, src, axis=0):
    return tgt.clone().index_add_(axis, idx, src)
def _segment_sum(src, seg, n):
    out = torch.zeros((n,) + src.shape[1:], dtype=src.dtype)
    return out.index_add_(0, seg, src)
def _pad(x, pw):
    flat = tuple(v for pair in reversed(pw) for v in pair)
    return torch.nn.functional.pad(x, flat)

kernel_name = 'recurrent_scan__linear_attn_block__mixer_token_mlp__prompt'

def setup_inputs():

    _w = (lambda a: (lambda t: t.to(torch.bfloat16) if t.is_floating_point() else t)(torch.as_tensor(a)))
    def _A_setup():
        B, S, D = 1, 2048, 512
        return {
            "x": _w((lambda *s: torch.randn(*s, dtype=torch.bfloat16) * 0.05)(B, S, D)),
            "wqkv": _w((lambda *s: torch.randn(*s, dtype=torch.bfloat16) * 0.2)(D, 3 * D)),
            "wo": _w((lambda *s: torch.randn(*s, dtype=torch.bfloat16) * 0.2)(D, D)),
        }
    _A_in = _A_setup()

    def _B_setup():
        B, S, D, F = 1, 2048, 512, 1376
        return {
            "x": _w((lambda *s: torch.randn(*s, dtype=torch.bfloat16) * 0.05)(B, S, D)),
            "w1": _w((lambda *s: torch.randn(*s, dtype=torch.bfloat16) * 0.4)(S, F) * (S ** -0.5)),
            "b1": _w((lambda *s: torch.randn(*s, dtype=torch.bfloat16) * 3.2)(F) * 0.02),
            "w2": _w((lambda *s: torch.randn(*s, dtype=torch.bfloat16) * 0.2)(F, S) * (F ** -0.5)),
            "b2": _w((lambda *s: torch.randn(*s, dtype=torch.bfloat16) * 0.4)(S) * 0.02),
        }
    _B_in = _B_setup()

    return {
        "A_x": _A_in["x"],
        "A_wqkv": _A_in["wqkv"],
        "A_wo": _A_in["wo"],
        "B_x": _B_in["x"],
        "B_w1": _B_in["w1"],
        "B_b1": _B_in["b1"],
        "B_w2": _B_in["w2"],
        "B_b2": _B_in["b2"],
    }

def reference(A_x, A_wqkv, A_wo, B_x, B_w1, B_b1, B_w2, B_b2):
    def _A_ref(x, wqkv, wo):
        B, S, D = x.shape
        H = 32; Dh = D // H
        qkv = (lambda x, *d: x.permute(*d))((x @ wqkv).reshape(B, S, 3, H, Dh), 2, 0, 3, 1, 4)
        q, k, v = qkv[0], qkv[1], qkv[2]
        phi = lambda t: torch.where(t > 0, t + 1, torch.exp(t)) + 1e-6
        pq, pk = phi(q), phi(k)
        kv = torch.einsum("bhsd,bhse->bhde", pk, v)
        z = torch.einsum("bhsd->bhd", pk)
        num = torch.einsum("bhqd,bhde->bhqe", pq, kv)
        den = torch.einsum("bhqd,bhd->bhq", pq, z)[..., None] + 1e-6
        o = num / den
        return (lambda x, *d: x.permute(*d))(o, 0, 2, 1, 3).reshape(B, S, D) @ wo

    def _B_ref(x, w1, b1, w2, b2):
        B, S, D = x.shape
        h = _layernorm(x, axis=-1)
        u = torch.einsum("bsd,sf->bdf", h, w1) + b1
        u = _gelu(u)
        y = torch.einsum("bdf,fs->bds", u, w2) + b2
        return (lambda x, *d: x.permute(*d))(y, 0, 2, 1)

    x = A_x
    xn = _layernorm(x, axis=-1)
    s = _A_ref(xn, A_wqkv, A_wo)
    g = _silu(_B_ref(xn, B_w1, B_b1, B_w2, B_b2))
    return x + s * g
```

```asm
; @launch grid=(256,1,1) block=(384,1,1) lds=163840
.amdgcn_target "amdgcn-amd-amdhsa--gfx950"
.text
.globl recurrent_scan__linear_attn_block__mixer_token_mlp__prompt_kernel
.p2align 8
.type recurrent_scan__linear_attn_block__mixer_token_mlp__prompt_kernel,@function
recurrent_scan__linear_attn_block__mixer_token_mlp__prompt_kernel:
    s_cmp_ge_u32 s2, 256
    s_cbranch_scc1 L_exit
    s_load_dwordx16 s[36:51], s[0:1], 0
    s_load_dwordx2 s[56:57], s[0:1], 64
    s_load_dwordx2 s[58:59], s[0:1], 80
    s_getpc_b64 s[64:65]
L_pc:
    s_lshr_b32 s55, s2, 3
    s_mul_i32 s60, s55, 1536
    v_lshrrev_b32 v2, 5, v0
    v_lshl_add_u32 v3, v2, 7, s60
    v_min_u32 v3, L_end-L_pc-4, v3
    global_load_dword v248, v3, s[64:65]
    v_readfirstlane_b32 s3, v2
    v_and_b32 v1, 63, v0
    s_and_b32 s33, s2, 7
    s_and_b32 s34, s33, 6
    s_lshl_b32 s34, s34, 2
    s_and_b32 s52, s55, 7
    s_add_u32 s34, s34, s52
    s_and_b32 s35, s33, 1
    s_lshl_b32 s35, s35, 2
    s_lshr_b32 s53, s55, 3
    s_add_u32 s35, s35, s53
    s_mov_b32 s10, 0x200000
    s_mov_b32 s11, 0x20000
    s_cmp_ge_u32 s3, 8
    s_cbranch_scc1 L_loader
    s_lshl_b32 s60, s34, 6
    s_lshl_b32 s61, s35, 3
    s_add_u32 s62, s60, s61
    s_lshl_b32 s65, s62, 10
    v_and_b32 v42, 31, v0
    v_lshlrev_b32 v3, 4, v42
    v_lshl_add_u32 v3, v2, 10, v3
    s_waitcnt lgkmcnt(0)
    s_mov_b64 s[8:9], s[36:37]
    buffer_load_dwordx4 v[112:115], v3, s[8:11], s65 offen
    buffer_load_dwordx4 v[116:119], v3, s[8:11], s65 offen offset:512
    s_load_dword s32, s[58:59], 0
    s_branch L_consumer
L_loader:
    s_lshr_b32 s3, s3, 1
    s_sub_u32 s55, s3, 4
    s_lshl_b32 s72, s55, 12
    s_add_u32 s73, s35, s34
    s_and_b32 s73, s73, 1
    s_mul_i32 s73, s73, 4
    s_mul_i32 s61, s33, 5
    s_lshr_b32 s61, s61, 1
    s_add_u32 s73, s73, s61
    s_and_b32 s73, s73, 7
    v_bfe_u32 v2, v0, 3, 4
    v_and_b32 v3, 7, v1
    v_lshrrev_b32 v4, 4, v1
    s_mul_i32 s60, s55, 24
    v_add_u32 v2, s60, v2
    v_mul_u32_u24 v33, 3072, v2
    s_lshl_b32 s60, s35, 7
    v_and_b32 v34, 1, v4
    v_lshlrev_b32 v6, 1, v34
    v_xor_b32 v6, v6, v3
    v_lshlrev_b32 v6, 4, v6
    v_xor_b32 v5, 64, v6
    v_add3_u32 v12, v33, v6, s60
    v_add3_u32 v5, v33, v5, s60
    v_add_u32 v13, 23552, v5
    v_add_u32 v14, 47104, v12
    v_add_u32 v15, 70656, v5
    s_mul_i32 s65, s73, 196608
    s_mov_b32 s14, 1572864
    s_mov_b32 s15, 0x20000
    s_waitcnt lgkmcnt(0)
    s_load_dword s32, s[58:59], 0
    s_mov_b64 s[8:9], s[36:37]
    s_mov_b64 s[12:13], s[38:39]
    s_add_u32 m0, s72, 0
    s_nop 0
    buffer_load_dwordx4 v12, s[12:15], s65 offen offset:0  lds
    buffer_load_dwordx4 v13, s[12:15], s65 offen offset:1024  lds
    buffer_load_dwordx4 v14, s[12:15], s65 offen offset:2048  lds
    buffer_load_dwordx4 v15, s[12:15], s65 offen offset:3072  lds
    s_add_u32 m0, s72, 8192
    s_add_u32 s74, s65, 1024
    buffer_load_dwordx4 v12, s[12:15], s74 offen offset:0  lds
    buffer_load_dwordx4 v13, s[12:15], s74 offen offset:1024  lds
    buffer_load_dwordx4 v14, s[12:15], s74 offen offset:2048  lds
    buffer_load_dwordx4 v15, s[12:15], s74 offen offset:3072  lds
    s_add_u32 m0, s72, 16384
    s_add_u32 s74, s65, 2048
    buffer_load_dwordx4 v12, s[12:15], s74 offen offset:0  lds
    buffer_load_dwordx4 v13, s[12:15], s74 offen offset:1024  lds
    buffer_load_dwordx4 v14, s[12:15], s74 offen offset:2048  lds
    buffer_load_dwordx4 v15, s[12:15], s74 offen offset:3072  lds
    s_add_u32 s65, s65, 196608
    s_cmp_eq_u32 s65, 1572864
    s_cselect_b32 s65, 0, s65
    s_add_u32 m0, s72, 24576
    s_lshl_b32 s60, s34, 16
    v_lshlrev_b32 v7, 10, v2
    v_xor_b32 v6, v3, v4
    v_lshlrev_b32 v6, 4, v6
    v_xor_b32 v5, 64, v6
    v_add3_u32 v8, v7, v6, s60
    v_add3_u32 v5, v7, v5, s60
    v_add_u32 v9, 7168, v5
    v_add_u32 v10, 14336, v8
    v_add_u32 v11, 21504, v5
    s_lshl_b32 s64, s73, 7
    buffer_load_dwordx4 v8, s[8:11], s64 offen offset:0  lds
    buffer_load_dwordx4 v9, s[8:11], s64 offen offset:1024  lds
    buffer_load_dwordx4 v10, s[8:11], s64 offen offset:2048  lds
    buffer_load_dwordx4 v11, s[8:11], s64 offen offset:3072  lds
    s_add_u32 s64, s64, 128
    s_and_b32 s64, s64, 1023
    s_mov_b64 s[4:5], s[58:59]
    s_mov_b64 s[16:17], s[44:45]
    s_mov_b64 s[20:21], s[40:41]
    s_mov_b64 s[24:25], s[48:49]
    s_lshr_b32 s60, s2, 3
    s_and_b32 s61, s33, 1
    s_mul_i32 s89, s61, 24
    s_add_u32 s89, s89, s60
    s_lshr_b32 s90, s33, 1
    s_lshl_b32 s61, s61, 2
    s_add_u32 s60, s60, s61
    s_cmp_lt_u32 s60, 24
    s_cselect_b32 s54, 1, 0
    s_lshr_b32 s53, s89, 2
    s_lshl_b32 s53, s53, 1
    s_and_b32 s61, s90, 1
    s_add_u32 s53, s53, s61
    s_and_b32 s88, s89, 3
    s_lshl_b32 s88, s88, 1
    s_lshr_b32 s61, s90, 1
    s_add_u32 s88, s88, s61
    v_lshlrev_b32 v6, 2, v34
    v_xor_b32 v6, v6, v3
    v_lshlrev_b32 v6, 4, v6
    v_mul_u32_u24 v5, 2752, v2
    s_mul_i32 s60, s90, 1409024
    v_add3_u32 v16, v5, v6, s60
    s_lshl_b32 s60, s35, 7
    v_add3_u32 v20, v7, v6, s60
    v_lshlrev_b32 v5, 12, v2
    s_lshl_b32 s60, s34, 7
    v_add3_u32 v24, v5, v6, s60
    v_add_u32 v17, 20992, v16
    v_add_u32 v21, 7168, v20
    v_add_u32 v25, 31744, v24
    v_add_u32 v18, 41984, v16
    v_add_u32 v22, 14336, v20
    v_add_u32 v26, 63488, v24
    v_add_u32 v19, 62976, v16
    v_add_u32 v23, 21504, v20
    v_add_u32 v27, 95232, v24
    v_lshlrev_b32 v5, 7, v2
    s_lshl_b32 s60, s90, 16
    s_add_u32 s60, s60, 2097152
    v_add3_u32 v28, v5, v6, s60
    s_lshl_b32 s84, s53, 7
    s_xor_b32 s85, s84, 128
    s_lshl_b32 s86, s88, 18
    s_xor_b32 s87, s86, 0x40000
    v_lshlrev_b32 v5, 4, v1
    v_add_u32 v5, s72, v5
    s_lshl_b32 s60, s34, 16
    s_add_u32 s60, s60, 4194304
    v_add_u32 v29, s60, v5
    s_mul_i32 s60, s35, 180224
    s_add_u32 s60, s60, 6291456
    v_add_u32 v30, s60, v5
    s_lshl_b32 s92, s34, 1
    s_add_u32 s92, s92, s55
    s_lshl_b32 s92, s92, 8
    s_add_u32 s60, s92, 393216
    v_lshl_add_u32 v31, v1, 2, s60
    s_lshl_b32 s60, s33, 12
    s_add_u32 s60, s60, 4096
    v_lshl_add_u32 v32, v1, 6, s60
    s_add_u32 s92, s92, 147456
    s_lshl_b32 s93, s35, 3
    s_and_b32 s61, s33, 6
    s_add_u32 s93, s93, s61
    s_add_u32 s93, s93, s55
    s_lshl_b32 s93, s93, 8
    s_add_u32 s94, s93, 131072
    s_lshl_b32 s93, s93, 2
    s_add_u32 s93, s93, 262144
    s_add_u32 s44, s58, s93
    s_addc_u32 s45, s59, 0
    s_lshr_b32 s60, s89, 2
    s_mul_i32 s60, s60, 3
    s_lshl_b32 s61, s89, 1
    s_add_u32 s60, s60, s61
    s_and_b32 s60, s60, 7
    s_mul_i32 s66, s60, 176128
    s_lshl_b32 s67, s60, 13
    s_lshl_b32 s68, s52, 16
    s_lshl_b32 s69, s52, 13
    s_add_u32 s60, s35, s34
    s_and_b32 s60, s60, 1
    s_mul_i32 s60, s60, 10
    s_lshl_b32 s70, s60, 18
    s_lshl_b32 s71, s60, 13
    s_mov_b32 s6, 20971520
    s_mov_b32 s7, 0x20000
    s_mov_b32 s22, 524288
    s_mov_b32 s23, 0x20000
    s_mov_b32 s26, 5636096
    s_mov_b32 s27, 0x20000
    s_mov_b32 s18, 5636096
    s_mov_b32 s19, 0x20000
    s_mov_b32 s99, 0x20000
    s_waitcnt lgkmcnt(0)
    s_mul_i32 s32, s32, 0x41c64e6d
    s_add_u32 s32, s32, 0x6f4a7c15
    s_cmp_eq_u32 s55, 0
    s_cselect_b64 s[28:29], s[46:47], s[50:51]
    s_cselect_b32 s60, s53, s34
    s_mul_i32 s30, s55, 1344
    s_add_u32 s30, s30, 2752
    s_mov_b32 s31, 0x20000
    s_lshl_b32 s60, s60, 7
    s_lshl_b32 s61, s55, 8
    s_add_u32 m0, s61, 156672
    v_lshlrev_b32 v5, 2, v1
    buffer_load_dword v5, s[28:31], s60 offen lds
    s_add_u32 m0, s72, 32768
    s_nop 0
    buffer_load_dwordx4 v12, s[12:15], s65 offen offset:0  lds
    buffer_load_dwordx4 v13, s[12:15], s65 offen offset:1024  lds
    buffer_load_dwordx4 v14, s[12:15], s65 offen offset:2048  lds
    buffer_load_dwordx4 v15, s[12:15], s65 offen offset:3072  lds
    s_add_u32 m0, s72, 40960
    s_add_u32 s74, s65, 1024
    buffer_load_dwordx4 v12, s[12:15], s74 offen offset:0  lds
    buffer_load_dwordx4 v13, s[12:15], s74 offen offset:1024  lds
    buffer_load_dwordx4 v14, s[12:15], s74 offen offset:2048  lds
    buffer_load_dwordx4 v15, s[12:15], s74 offen offset:3072  lds
    s_add_u32 m0, s72, 49152
    s_add_u32 s74, s65, 2048
    buffer_load_dwordx4 v12, s[12:15], s74 offen offset:0  lds
    buffer_load_dwordx4 v13, s[12:15], s74 offen offset:1024  lds
    buffer_load_dwordx4 v14, s[12:15], s74 offen offset:2048  lds
    buffer_load_dwordx4 v15, s[12:15], s74 offen offset:3072  lds
    s_add_u32 s65, s65, 196608
    s_cmp_eq_u32 s65, 1572864
    s_cselect_b32 s65, 0, s65
    s_add_u32 m0, s72, 57344
    s_nop 0
    buffer_load_dwordx4 v8, s[8:11], s64 offen offset:0  lds
    buffer_load_dwordx4 v9, s[8:11], s64 offen offset:1024  lds
    buffer_load_dwordx4 v10, s[8:11], s64 offen offset:2048  lds
    buffer_load_dwordx4 v11, s[8:11], s64 offen offset:3072  lds
    s_add_u32 s64, s64, 128
    s_and_b32 s64, s64, 1023
    s_add_u32 m0, s72, 65536
    s_nop 0
    buffer_load_dwordx4 v12, s[12:15], s65 offen offset:0  lds
    buffer_load_dwordx4 v13, s[12:15], s65 offen offset:1024  lds
    buffer_load_dwordx4 v14, s[12:15], s65 offen offset:2048  lds
    buffer_load_dwordx4 v15, s[12:15], s65 offen offset:3072  lds
    s_waitcnt vmcnt(21)
    s_barrier
    s_add_u32 m0, s72, 73728
    s_add_u32 s74, s65, 1024
    buffer_load_dwordx4 v12, s[12:15], s74 offen offset:0  lds
    buffer_load_dwordx4 v13, s[12:15], s74 offen offset:1024  lds
    buffer_load_dwordx4 v14, s[12:15], s74 offen offset:2048  lds
    buffer_load_dwordx4 v15, s[12:15], s74 offen offset:3072  lds
    s_add_u32 m0, s72, 81920
    s_add_u32 s74, s65, 2048
    buffer_load_dwordx4 v12, s[12:15], s74 offen offset:0  lds
    buffer_load_dwordx4 v13, s[12:15], s74 offen offset:1024  lds
    buffer_load_dwordx4 v14, s[12:15], s74 offen offset:2048  lds
    buffer_load_dwordx4 v15, s[12:15], s74 offen offset:3072  lds
    s_add_u32 s65, s65, 196608
    s_cmp_eq_u32 s65, 1572864
    s_cselect_b32 s65, 0, s65
    s_add_u32 m0, s72, 90112
    s_nop 0
    buffer_load_dwordx4 v8, s[8:11], s64 offen offset:0  lds
    buffer_load_dwordx4 v9, s[8:11], s64 offen offset:1024  lds
    buffer_load_dwordx4 v10, s[8:11], s64 offen offset:2048  lds
    buffer_load_dwordx4 v11, s[8:11], s64 offen offset:3072  lds
    s_add_u32 s64, s64, 128
    s_and_b32 s64, s64, 1023
    s_add_u32 m0, s72, 98304
    s_nop 0
    buffer_load_dwordx4 v12, s[12:15], s65 offen offset:0  lds
    buffer_load_dwordx4 v13, s[12:15], s65 offen offset:1024  lds
    buffer_load_dwordx4 v14, s[12:15], s65 offen offset:2048  lds
    buffer_load_dwordx4 v15, s[12:15], s65 offen offset:3072  lds
    s_waitcnt vmcnt(20)
    s_barrier
    s_add_u32 m0, s72, 106496
    s_add_u32 s74, s65, 1024
    buffer_load_dwordx4 v12, s[12:15], s74 offen offset:0  lds
    buffer_load_dwordx4 v13, s[12:15], s74 offen offset:1024  lds
    buffer_load_dwordx4 v14, s[12:15], s74 offen offset:2048  lds
    buffer_load_dwordx4 v15, s[12:15], s74 offen offset:3072  lds
    s_add_u32 m0, s72, 114688
    s_add_u32 s74, s65, 2048
    buffer_load_dwordx4 v12, s[12:15], s74 offen offset:0  lds
    buffer_load_dwordx4 v13, s[12:15], s74 offen offset:1024  lds
    buffer_load_dwordx4 v14, s[12:15], s74 offen offset:2048  lds
    buffer_load_dwordx4 v15, s[12:15], s74 offen offset:3072  lds
    s_add_u32 s65, s65, 196608
    s_cmp_eq_u32 s65, 1572864
    s_cselect_b32 s65, 0, s65
    s_add_u32 m0, s72, 122880
    s_nop 0
    buffer_load_dwordx4 v8, s[8:11], s64 offen offset:0  lds
    buffer_load_dwordx4 v9, s[8:11], s64 offen offset:1024  lds
    buffer_load_dwordx4 v10, s[8:11], s64 offen offset:2048  lds
    buffer_load_dwordx4 v11, s[8:11], s64 offen offset:3072  lds
    s_add_u32 s64, s64, 128
    s_and_b32 s64, s64, 1023
    s_add_u32 m0, s72, 131072
    s_nop 0
    buffer_load_dwordx4 v12, s[12:15], s65 offen offset:0  lds
    buffer_load_dwordx4 v13, s[12:15], s65 offen offset:1024  lds
    buffer_load_dwordx4 v14, s[12:15], s65 offen offset:2048  lds
    buffer_load_dwordx4 v15, s[12:15], s65 offen offset:3072  lds
    s_waitcnt vmcnt(20)
    s_barrier
    s_add_u32 m0, s72, 139264
    s_add_u32 s74, s65, 1024
    buffer_load_dwordx4 v12, s[12:15], s74 offen offset:0  lds
    buffer_load_dwordx4 v13, s[12:15], s74 offen offset:1024  lds
    buffer_load_dwordx4 v14, s[12:15], s74 offen offset:2048  lds
    buffer_load_dwordx4 v15, s[12:15], s74 offen offset:3072  lds
    s_add_u32 m0, s72, 147456
    s_add_u32 s74, s65, 2048
    buffer_load_dwordx4 v12, s[12:15], s74 offen offset:0  lds
    buffer_load_dwordx4 v13, s[12:15], s74 offen offset:1024  lds
    buffer_load_dwordx4 v14, s[12:15], s74 offen offset:2048  lds
    buffer_load_dwordx4 v15, s[12:15], s74 offen offset:3072  lds
    s_add_u32 s65, s65, 196608
    s_cmp_eq_u32 s65, 1572864
    s_cselect_b32 s65, 0, s65
    s_add_u32 m0, s72, 0
    s_nop 0
    buffer_load_dwordx4 v8, s[8:11], s64 offen offset:0  lds
    buffer_load_dwordx4 v9, s[8:11], s64 offen offset:1024  lds
    buffer_load_dwordx4 v10, s[8:11], s64 offen offset:2048  lds
    buffer_load_dwordx4 v11, s[8:11], s64 offen offset:3072  lds
    s_add_u32 s64, s64, 128
    s_and_b32 s64, s64, 1023
    s_add_u32 m0, s72, 8192
    s_nop 0
    buffer_load_dwordx4 v12, s[12:15], s65 offen offset:0  lds
    buffer_load_dwordx4 v13, s[12:15], s65 offen offset:1024  lds
    buffer_load_dwordx4 v14, s[12:15], s65 offen offset:2048  lds
    buffer_load_dwordx4 v15, s[12:15], s65 offen offset:3072  lds
    s_waitcnt vmcnt(20)
    s_barrier
    s_add_u32 m0, s72, 16384
    s_add_u32 s74, s65, 1024
    buffer_load_dwordx4 v12, s[12:15], s74 offen offset:0  lds
    buffer_load_dwordx4 v13, s[12:15], s74 offen offset:1024  lds
    buffer_load_dwordx4 v14, s[12:15], s74 offen offset:2048  lds
    buffer_load_dwordx4 v15, s[12:15], s74 offen offset:3072  lds
    s_add_u32 m0, s72, 24576
    s_add_u32 s74, s65, 2048
    buffer_load_dwordx4 v12, s[12:15], s74 offen offset:0  lds
    buffer_load_dwordx4 v13, s[12:15], s74 offen offset:1024  lds
    buffer_load_dwordx4 v14, s[12:15], s74 offen offset:2048  lds
    buffer_load_dwordx4 v15, s[12:15], s74 offen offset:3072  lds
    s_add_u32 s65, s65, 196608
    s_cmp_eq_u32 s65, 1572864
    s_cselect_b32 s65, 0, s65
    s_add_u32 m0, s72, 32768
    s_nop 0
    buffer_load_dwordx4 v8, s[8:11], s64 offen offset:0  lds
    buffer_load_dwordx4 v9, s[8:11], s64 offen offset:1024  lds
    buffer_load_dwordx4 v10, s[8:11], s64 offen offset:2048  lds
    buffer_load_dwordx4 v11, s[8:11], s64 offen offset:3072  lds
    s_add_u32 s64, s64, 128
    s_and_b32 s64, s64, 1023
    s_add_u32 m0, s72, 40960
    s_nop 0
    buffer_load_dwordx4 v12, s[12:15], s65 offen offset:0  lds
    buffer_load_dwordx4 v13, s[12:15], s65 offen offset:1024  lds
    buffer_load_dwordx4 v14, s[12:15], s65 offen offset:2048  lds
    buffer_load_dwordx4 v15, s[12:15], s65 offen offset:3072  lds
    s_waitcnt vmcnt(20)
    s_barrier
    s_add_u32 m0, s72, 49152
    s_add_u32 s74, s65, 1024
    buffer_load_dwordx4 v12, s[12:15], s74 offen offset:0  lds
    buffer_load_dwordx4 v13, s[12:15], s74 offen offset:1024  lds
    buffer_load_dwordx4 v14, s[12:15], s74 offen offset:2048  lds
    buffer_load_dwordx4 v15, s[12:15], s74 offen offset:3072  lds
    s_add_u32 m0, s72, 57344
    s_add_u32 s74, s65, 2048
    buffer_load_dwordx4 v12, s[12:15], s74 offen offset:0  lds
    buffer_load_dwordx4 v13, s[12:15], s74 offen offset:1024  lds
    buffer_load_dwordx4 v14, s[12:15], s74 offen offset:2048  lds
    buffer_load_dwordx4 v15, s[12:15], s74 offen offset:3072  lds
    s_add_u32 s65, s65, 196608
    s_cmp_eq_u32 s65, 1572864
    s_cselect_b32 s65, 0, s65
    s_add_u32 m0, s72, 65536
    s_nop 0
    buffer_load_dwordx4 v8, s[8:11], s64 offen offset:0  lds
    buffer_load_dwordx4 v9, s[8:11], s64 offen offset:1024  lds
    buffer_load_dwordx4 v10, s[8:11], s64 offen offset:2048  lds
    buffer_load_dwordx4 v11, s[8:11], s64 offen offset:3072  lds
    s_add_u32 s64, s64, 128
    s_and_b32 s64, s64, 1023
    s_waitcnt vmcnt(16)
    s_barrier
    buffer_load_dwordx4 v[40:43], v32, s[4:7], 0 offen sc1
    s_add_u32 m0, s72, 73728
    s_nop 0
    buffer_load_dwordx4 v12, s[12:15], s65 offen offset:0  lds
    buffer_load_dwordx4 v13, s[12:15], s65 offen offset:1024  lds
    buffer_load_dwordx4 v14, s[12:15], s65 offen offset:2048  lds
    buffer_load_dwordx4 v15, s[12:15], s65 offen offset:3072  lds
    s_add_u32 m0, s72, 81920
    s_add_u32 s74, s65, 1024
    buffer_load_dwordx4 v12, s[12:15], s74 offen offset:0  lds
    buffer_load_dwordx4 v13, s[12:15], s74 offen offset:1024  lds
    buffer_load_dwordx4 v14, s[12:15], s74 offen offset:2048  lds
    buffer_load_dwordx4 v15, s[12:15], s74 offen offset:3072  lds
    s_add_u32 m0, s72, 90112
    s_add_u32 s74, s65, 2048
    buffer_load_dwordx4 v12, s[12:15], s74 offen offset:0  lds
    buffer_load_dwordx4 v13, s[12:15], s74 offen offset:1024  lds
    buffer_load_dwordx4 v14, s[12:15], s74 offen offset:2048  lds
    buffer_load_dwordx4 v15, s[12:15], s74 offen offset:3072  lds
    s_add_u32 s65, s65, 196608
    s_cmp_eq_u32 s65, 1572864
    s_cselect_b32 s65, 0, s65
    s_add_u32 m0, s72, 98304
    s_nop 0
    buffer_load_dwordx4 v8, s[8:11], s64 offen offset:0  lds
    buffer_load_dwordx4 v9, s[8:11], s64 offen offset:1024  lds
    buffer_load_dwordx4 v10, s[8:11], s64 offen offset:2048  lds
    buffer_load_dwordx4 v11, s[8:11], s64 offen offset:3072  lds
    s_add_u32 s64, s64, 128
    s_and_b32 s64, s64, 1023
    s_waitcnt vmcnt(17)
    s_barrier
    s_mov_b32 s75, 0
    s_waitcnt vmcnt(16)
L_chk_F0:
    v_xor_b32 v40, s32, v40
    v_xor_b32 v41, s32, v41
    v_xor_b32 v42, s32, v42
    v_xor_b32 v43, s32, v43
    v_or3_b32 v40, v40, v41, v42
    v_or_b32 v40, v40, v43
    v_cmp_ne_u32 vcc, 0, v40
    s_cbranch_vccz L_ok_F0
    s_add_u32 s75, s75, 1
    s_cmp_gt_u32 s75, 20000
    s_cbranch_scc1 L_ok_F0
    s_sleep 8
    buffer_load_dwordx4 v[40:43], v32, s[4:7], 0 offen sc1
    s_waitcnt vmcnt(0)
    s_branch L_chk_F0
L_ok_F0:
    s_lshl_b32 s60, s55, 8
    s_add_u32 m0, s60, 155648
    s_nop 0
    buffer_load_dword v31, s[4:7], 0 offen sc1 lds
    s_cmp_eq_u32 s54, 0
    s_cbranch_scc1 L_lhelper
    s_add_u32 m0, s72, 106496
    s_add_u32 s74, s66, s84
    buffer_load_dwordx4 v16, s[16:19], s74 offen offset:0  lds
    buffer_load_dwordx4 v17, s[16:19], s74 offen offset:1024  lds
    buffer_load_dwordx4 v18, s[16:19], s74 offen offset:2048  lds
    buffer_load_dwordx4 v19, s[16:19], s74 offen offset:3072  lds
    s_add_u32 m0, s72, 114688
    s_add_u32 s74, s66, s85
    buffer_load_dwordx4 v16, s[16:19], s74 offen offset:0  lds
    buffer_load_dwordx4 v17, s[16:19], s74 offen offset:1024  lds
    buffer_load_dwordx4 v18, s[16:19], s74 offen offset:2048  lds
    buffer_load_dwordx4 v19, s[16:19], s74 offen offset:3072  lds
    s_add_u32 s66, s66, 176128
    s_cmp_eq_u32 s66, 1409024
    s_cselect_b32 s66, 0, s66
    s_add_u32 m0, s72, 122880
    s_add_u32 s74, s67, s86
    buffer_load_dwordx4 v28, s[4:7], s74 offen offset:0 sc1 lds
    buffer_load_dwordx4 v28, s[4:7], s74 offen offset:1024 sc1 lds
    buffer_load_dwordx4 v28, s[4:7], s74 offen offset:2048 sc1 lds
    buffer_load_dwordx4 v28, s[4:7], s74 offen offset:3072 sc1 lds
    s_waitcnt vmcnt(13)
    s_barrier
    s_add_u32 m0, s72, 131072
    s_add_u32 s74, s67, s87
    buffer_load_dwordx4 v28, s[4:7], s74 offen offset:0 sc1 lds
    buffer_load_dwordx4 v28, s[4:7], s74 offen offset:1024 sc1 lds
    buffer_load_dwordx4 v28, s[4:7], s74 offen offset:2048 sc1 lds
    buffer_load_dwordx4 v28, s[4:7], s74 offen offset:3072 sc1 lds
    s_add_u32 s67, s67, 8192
    s_and_b32 s67, s67, 65535
    s_waitcnt vmcnt(16)
    s_barrier
    s_add_u32 m0, s72, 139264
    s_add_u32 s74, s66, s84
    buffer_load_dwordx4 v16, s[16:19], s74 offen offset:0  lds
    buffer_load_dwordx4 v17, s[16:19], s74 offen offset:1024  lds
    buffer_load_dwordx4 v18, s[16:19], s74 offen offset:2048  lds
    buffer_load_dwordx4 v19, s[16:19], s74 offen offset:3072  lds
    s_add_u32 m0, s72, 147456
    s_add_u32 s74, s66, s85
    buffer_load_dwordx4 v16, s[16:19], s74 offen offset:0  lds
    buffer_load_dwordx4 v17, s[16:19], s74 offen offset:1024  lds
    buffer_load_dwordx4 v18, s[16:19], s74 offen offset:2048  lds
    buffer_load_dwordx4 v19, s[16:19], s74 offen offset:3072  lds
    s_add_u32 s66, s66, 176128
    s_cmp_eq_u32 s66, 1409024
    s_cselect_b32 s66, 0, s66
    s_add_u32 m0, s72, 0
    s_add_u32 s74, s67, s86
    buffer_load_dwordx4 v28, s[4:7], s74 offen offset:0 sc1 lds
    buffer_load_dwordx4 v28, s[4:7], s74 offen offset:1024 sc1 lds
    buffer_load_dwordx4 v28, s[4:7], s74 offen offset:2048 sc1 lds
    buffer_load_dwordx4 v28, s[4:7], s74 offen offset:3072 sc1 lds
    s_add_u32 m0, s72, 8192
    s_add_u32 s74, s67, s87
    buffer_load_dwordx4 v28, s[4:7], s74 offen offset:0 sc1 lds
    buffer_load_dwordx4 v28, s[4:7], s74 offen offset:1024 sc1 lds
    buffer_load_dwordx4 v28, s[4:7], s74 offen offset:2048 sc1 lds
    buffer_load_dwordx4 v28, s[4:7], s74 offen offset:3072 sc1 lds
    s_add_u32 s67, s67, 8192
    s_and_b32 s67, s67, 65535
    s_add_u32 m0, s72, 16384
    s_add_u32 s74, s66, s84
    buffer_load_dwordx4 v16, s[16:19], s74 offen offset:0  lds
    buffer_load_dwordx4 v17, s[16:19], s74 offen offset:1024  lds
    buffer_load_dwordx4 v18, s[16:19], s74 offen offset:2048  lds
    buffer_load_dwordx4 v19, s[16:19], s74 offen offset:3072  lds
    s_waitcnt vmcnt(20)
    s_barrier
    s_add_u32 m0, s72, 24576
    s_add_u32 s74, s66, s85
    buffer_load_dwordx4 v16, s[16:19], s74 offen offset:0  lds
    buffer_load_dwordx4 v17, s[16:19], s74 offen offset:1024  lds
    buffer_load_dwordx4 v18, s[16:19], s74 offen offset:2048  lds
    buffer_load_dwordx4 v19, s[16:19], s74 offen offset:3072  lds
    s_add_u32 s66, s66, 176128
    s_cmp_eq_u32 s66, 1409024
    s_cselect_b32 s66, 0, s66
    s_add_u32 m0, s72, 32768
    s_add_u32 s74, s67, s86
    buffer_load_dwordx4 v28, s[4:7], s74 offen offset:0 sc1 lds
    buffer_load_dwordx4 v28, s[4:7], s74 offen offset:1024 sc1 lds
    buffer_load_dwordx4 v28, s[4:7], s74 offen offset:2048 sc1 lds
    buffer_load_dwordx4 v28, s[4:7], s74 offen offset:3072 sc1 lds
    s_add_u32 m0, s72, 40960
    s_add_u32 s74, s67, s87
    buffer_load_dwordx4 v28, s[4:7], s74 offen offset:0 sc1 lds
    buffer_load_dwordx4 v28, s[4:7], s74 offen offset:1024 sc1 lds
    buffer_load_dwordx4 v28, s[4:7], s74 offen offset:2048 sc1 lds
    buffer_load_dwordx4 v28, s[4:7], s74 offen offset:3072 sc1 lds
    s_add_u32 s67, s67, 8192
    s_and_b32 s67, s67, 65535
    s_add_u32 m0, s72, 49152
    s_add_u32 s74, s66, s84
    buffer_load_dwordx4 v16, s[16:19], s74 offen offset:0  lds
    buffer_load_dwordx4 v17, s[16:19], s74 offen offset:1024  lds
    buffer_load_dwordx4 v18, s[16:19], s74 offen offset:2048  lds
    buffer_load_dwordx4 v19, s[16:19], s74 offen offset:3072  lds
    s_waitcnt vmcnt(20)
    s_barrier
    s_add_u32 m0, s72, 57344
    s_add_u32 s74, s66, s85
    buffer_load_dwordx4 v16, s[16:19], s74 offen offset:0  lds
    buffer_load_dwordx4 v17, s[16:19], s74 offen offset:1024  lds
    buffer_load_dwordx4 v18, s[16:19], s74 offen offset:2048  lds
    buffer_load_dwordx4 v19, s[16:19], s74 offen offset:3072  lds
    s_add_u32 s66, s66, 176128
    s_cmp_eq_u32 s66, 1409024
    s_cselect_b32 s66, 0, s66
    s_add_u32 m0, s72, 65536
    s_add_u32 s74, s67, s86
    buffer_load_dwordx4 v28, s[4:7], s74 offen offset:0 sc1 lds
    buffer_load_dwordx4 v28, s[4:7], s74 offen offset:1024 sc1 lds
    buffer_load_dwordx4 v28, s[4:7], s74 offen offset:2048 sc1 lds
    buffer_load_dwordx4 v28, s[4:7], s74 offen offset:3072 sc1 lds
    s_add_u32 m0, s72, 73728
    s_add_u32 s74, s67, s87
    buffer_load_dwordx4 v28, s[4:7], s74 offen offset:0 sc1 lds
    buffer_load_dwordx4 v28, s[4:7], s74 offen offset:1024 sc1 lds
    buffer_load_dwordx4 v28, s[4:7], s74 offen offset:2048 sc1 lds
    buffer_load_dwordx4 v28, s[4:7], s74 offen offset:3072 sc1 lds
    s_add_u32 s67, s67, 8192
    s_and_b32 s67, s67, 65535
    s_add_u32 m0, s72, 81920
    s_add_u32 s74, s66, s84
    buffer_load_dwordx4 v16, s[16:19], s74 offen offset:0  lds
    buffer_load_dwordx4 v17, s[16:19], s74 offen offset:1024  lds
    buffer_load_dwordx4 v18, s[16:19], s74 offen offset:2048  lds
    buffer_load_dwordx4 v19, s[16:19], s74 offen offset:3072  lds
    s_waitcnt vmcnt(20)
    s_barrier
    s_add_u32 m0, s72, 90112
    s_add_u32 s74, s66, s85
    buffer_load_dwordx4 v16, s[16:19], s74 offen offset:0  lds
    buffer_load_dwordx4 v17, s[16:19], s74 offen offset:1024  lds
    buffer_load_dwordx4 v18, s[16:19], s74 offen offset:2048  lds
    buffer_load_dwordx4 v19, s[16:19], s74 offen offset:3072  lds
    s_add_u32 s66, s66, 176128
    s_cmp_eq_u32 s66, 1409024
    s_cselect_b32 s66, 0, s66
    s_add_u32 m0, s72, 98304
    s_add_u32 s74, s67, s86
    buffer_load_dwordx4 v28, s[4:7], s74 offen offset:0 sc1 lds
    buffer_load_dwordx4 v28, s[4:7], s74 offen offset:1024 sc1 lds
    buffer_load_dwordx4 v28, s[4:7], s74 offen offset:2048 sc1 lds
    buffer_load_dwordx4 v28, s[4:7], s74 offen offset:3072 sc1 lds
    s_add_u32 m0, s72, 106496
    s_add_u32 s74, s67, s87
    buffer_load_dwordx4 v28, s[4:7], s74 offen offset:0 sc1 lds
    buffer_load_dwordx4 v28, s[4:7], s74 offen offset:1024 sc1 lds
    buffer_load_dwordx4 v28, s[4:7], s74 offen offset:2048 sc1 lds
    buffer_load_dwordx4 v28, s[4:7], s74 offen offset:3072 sc1 lds
    s_add_u32 s67, s67, 8192
    s_and_b32 s67, s67, 65535
    s_add_u32 m0, s72, 114688
    s_add_u32 s74, s66, s84
    buffer_load_dwordx4 v16, s[16:19], s74 offen offset:0  lds
    buffer_load_dwordx4 v17, s[16:19], s74 offen offset:1024  lds
    buffer_load_dwordx4 v18, s[16:19], s74 offen offset:2048  lds
    buffer_load_dwordx4 v19, s[16:19], s74 offen offset:3072  lds
    s_waitcnt vmcnt(20)
    s_barrier
    s_add_u32 m0, s72, 122880
    s_add_u32 s74, s66, s85
    buffer_load_dwordx4 v16, s[16:19], s74 offen offset:0  lds
    buffer_load_dwordx4 v17, s[16:19], s74 offen offset:1024  lds
    buffer_load_dwordx4 v18, s[16:19], s74 offen offset:2048  lds
    buffer_load_dwordx4 v19, s[16:19], s74 offen offset:3072  lds
    s_add_u32 s66, s66, 176128
    s_cmp_eq_u32 s66, 1409024
    s_cselect_b32 s66, 0, s66
    s_add_u32 m0, s72, 131072
    s_add_u32 s74, s67, s86
    buffer_load_dwordx4 v28, s[4:7], s74 offen offset:0 sc1 lds
    buffer_load_dwordx4 v28, s[4:7], s74 offen offset:1024 sc1 lds
    buffer_load_dwordx4 v28, s[4:7], s74 offen offset:2048 sc1 lds
    buffer_load_dwordx4 v28, s[4:7], s74 offen offset:3072 sc1 lds
    s_add_u32 m0, s72, 139264
    s_add_u32 s74, s67, s87
    buffer_load_dwordx4 v28, s[4:7], s74 offen offset:0 sc1 lds
    buffer_load_dwordx4 v28, s[4:7], s74 offen offset:1024 sc1 lds
    buffer_load_dwordx4 v28, s[4:7], s74 offen offset:2048 sc1 lds
    buffer_load_dwordx4 v28, s[4:7], s74 offen offset:3072 sc1 lds
    s_add_u32 s67, s67, 8192
    s_and_b32 s67, s67, 65535
    s_add_u32 m0, s72, 147456
    s_add_u32 s74, s66, s84
    buffer_load_dwordx4 v16, s[16:19], s74 offen offset:0  lds
    buffer_load_dwordx4 v17, s[16:19], s74 offen offset:1024  lds
    buffer_load_dwordx4 v18, s[16:19], s74 offen offset:2048  lds
    buffer_load_dwordx4 v19, s[16:19], s74 offen offset:3072  lds
    s_waitcnt vmcnt(20)
    s_barrier
    s_add_u32 m0, s72, 0
    s_add_u32 s74, s66, s85
    buffer_load_dwordx4 v16, s[16:19], s74 offen offset:0  lds
    buffer_load_dwordx4 v17, s[16:19], s74 offen offset:1024  lds
    buffer_load_dwordx4 v18, s[16:19], s74 offen offset:2048  lds
    buffer_load_dwordx4 v19, s[16:19], s74 offen offset:3072  lds
    s_add_u32 s66, s66, 176128
    s_cmp_eq_u32 s66, 1409024
    s_cselect_b32 s66, 0, s66
    s_add_u32 m0, s72, 8192
    s_add_u32 s74, s67, s86
    buffer_load_dwordx4 v28, s[4:7], s74 offen offset:0 sc1 lds
    buffer_load_dwordx4 v28, s[4:7], s74 offen offset:1024 sc1 lds
    buffer_load_dwordx4 v28, s[4:7], s74 offen offset:2048 sc1 lds
    buffer_load_dwordx4 v28, s[4:7], s74 offen offset:3072 sc1 lds
    s_add_u32 m0, s72, 16384
    s_add_u32 s74, s67, s87
    buffer_load_dwordx4 v28, s[4:7], s74 offen offset:0 sc1 lds
    buffer_load_dwordx4 v28, s[4:7], s74 offen offset:1024 sc1 lds
    buffer_load_dwordx4 v28, s[4:7], s74 offen offset:2048 sc1 lds
    buffer_load_dwordx4 v28, s[4:7], s74 offen offset:3072 sc1 lds
    s_add_u32 s67, s67, 8192
    s_and_b32 s67, s67, 65535
    s_add_u32 m0, s72, 24576
    s_add_u32 s74, s66, s84
    buffer_load_dwordx4 v16, s[16:19], s74 offen offset:0  lds
    buffer_load_dwordx4 v17, s[16:19], s74 offen offset:1024  lds
    buffer_load_dwordx4 v18, s[16:19], s74 offen offset:2048  lds
    buffer_load_dwordx4 v19, s[16:19], s74 offen offset:3072  lds
    s_waitcnt vmcnt(20)
    s_barrier
    s_add_u32 m0, s72, 32768
    s_add_u32 s74, s66, s85
    buffer_load_dwordx4 v16, s[16:19], s74 offen offset:0  lds
    buffer_load_dwordx4 v17, s[16:19], s74 offen offset:1024  lds
    buffer_load_dwordx4 v18, s[16:19], s74 offen offset:2048  lds
    buffer_load_dwordx4 v19, s[16:19], s74 offen offset:3072  lds
    s_add_u32 s66, s66, 176128
    s_cmp_eq_u32 s66, 1409024
    s_cselect_b32 s66, 0, s66
    s_add_u32 m0, s72, 40960
    s_add_u32 s74, s67, s86
    buffer_load_dwordx4 v28, s[4:7], s74 offen offset:0 sc1 lds
    buffer_load_dwordx4 v28, s[4:7], s74 offen offset:1024 sc1 lds
    buffer_load_dwordx4 v28, s[4:7], s74 offen offset:2048 sc1 lds
    buffer_load_dwordx4 v28, s[4:7], s74 offen offset:3072 sc1 lds
    s_add_u32 m0, s72, 49152
    s_add_u32 s74, s67, s87
    buffer_load_dwordx4 v28, s[4:7], s74 offen offset:0 sc1 lds
    buffer_load_dwordx4 v28, s[4:7], s74 offen offset:1024 sc1 lds
    buffer_load_dwordx4 v28, s[4:7], s74 offen offset:2048 sc1 lds
    buffer_load_dwordx4 v28, s[4:7], s74 offen offset:3072 sc1 lds
    s_add_u32 s67, s67, 8192
    s_and_b32 s67, s67, 65535
    s_add_u32 m0, s72, 57344
    s_mov_b32 s74, 5505024
    buffer_load_dwordx4 v24, s[24:27], s74 offen offset:0  lds
    buffer_load_dwordx4 v25, s[24:27], s74 offen offset:1024  lds
    buffer_load_dwordx4 v26, s[24:27], s74 offen offset:2048  lds
    buffer_load_dwordx4 v27, s[24:27], s74 offen offset:3072  lds
    s_waitcnt vmcnt(20)
    s_barrier
    s_add_u32 m0, s72, 65536
    s_nop 0
    buffer_load_dwordx4 v24, s[24:27], s70 offen offset:0  lds
    buffer_load_dwordx4 v25, s[24:27], s70 offen offset:1024  lds
    buffer_load_dwordx4 v26, s[24:27], s70 offen offset:2048  lds
    buffer_load_dwordx4 v27, s[24:27], s70 offen offset:3072  lds
    s_add_u32 s70, s70, 262144
    s_cmp_eq_u32 s70, 5505024
    s_cselect_b32 s70, 0, s70
    s_add_u32 m0, s72, 73728
    s_nop 0
    buffer_load_dwordx4 v24, s[24:27], s70 offen offset:0  lds
    buffer_load_dwordx4 v25, s[24:27], s70 offen offset:1024  lds
    buffer_load_dwordx4 v26, s[24:27], s70 offen offset:2048  lds
    buffer_load_dwordx4 v27, s[24:27], s70 offen offset:3072  lds
    s_add_u32 s70, s70, 262144
    s_cmp_eq_u32 s70, 5505024
    s_cselect_b32 s70, 0, s70
    s_add_u32 m0, s72, 81920
    s_nop 0
    buffer_load_dwordx4 v24, s[24:27], s70 offen offset:0  lds
    buffer_load_dwordx4 v25, s[24:27], s70 offen offset:1024  lds
    buffer_load_dwordx4 v26, s[24:27], s70 offen offset:2048  lds
    buffer_load_dwordx4 v27, s[24:27], s70 offen offset:3072  lds
    s_add_u32 s70, s70, 262144
    s_cmp_eq_u32 s70, 5505024
    s_cselect_b32 s70, 0, s70
    s_add_u32 m0, s72, 90112
    s_nop 0
    buffer_load_dwordx4 v24, s[24:27], s70 offen offset:0  lds
    buffer_load_dwordx4 v25, s[24:27], s70 offen offset:1024  lds
    buffer_load_dwordx4 v26, s[24:27], s70 offen offset:2048  lds
    buffer_load_dwordx4 v27, s[24:27], s70 offen offset:3072  lds
    s_add_u32 s70, s70, 262144
    s_cmp_eq_u32 s70, 5505024
    s_cselect_b32 s70, 0, s70
    s_mov_b32 s36, 0
    s_atomic_add s36, s[58:59], s94 glc
    s_waitcnt vmcnt(20)
    s_barrier
    s_add_u32 m0, s72, 98304
    s_nop 0
    buffer_load_dwordx4 v24, s[24:27], s70 offen offset:0  lds
    buffer_load_dwordx4 v25, s[24:27], s70 offen offset:1024  lds
    buffer_load_dwordx4 v26, s[24:27], s70 offen offset:2048  lds
    buffer_load_dwordx4 v27, s[24:27], s70 offen offset:3072  lds
    s_add_u32 s70, s70, 262144
    s_cmp_eq_u32 s70, 5505024
    s_cselect_b32 s70, 0, s70
    s_add_u32 m0, s72, 106496
    s_nop 0
    buffer_load_dwordx4 v24, s[24:27], s70 offen offset:0  lds
    buffer_load_dwordx4 v25, s[24:27], s70 offen offset:1024  lds
    buffer_load_dwordx4 v26, s[24:27], s70 offen offset:2048  lds
    buffer_load_dwordx4 v27, s[24:27], s70 offen offset:3072  lds
    s_add_u32 s70, s70, 262144
    s_cmp_eq_u32 s70, 5505024
    s_cselect_b32 s70, 0, s70
    s_add_u32 m0, s72, 114688
    s_nop 0
    buffer_load_dwordx4 v20, s[20:23], s68 offen offset:0  lds
    buffer_load_dwordx4 v21, s[20:23], s68 offen offset:1024  lds
    buffer_load_dwordx4 v22, s[20:23], s68 offen offset:2048  lds
    buffer_load_dwordx4 v23, s[20:23], s68 offen offset:3072  lds
    s_add_u32 s68, s68, 65536
    s_and_b32 s68, s68, 524287
    s_add_u32 m0, s72, 122880
    s_nop 0
    buffer_load_dwordx4 v20, s[20:23], s68 offen offset:0  lds
    buffer_load_dwordx4 v21, s[20:23], s68 offen offset:1024  lds
    buffer_load_dwordx4 v22, s[20:23], s68 offen offset:2048  lds
    buffer_load_dwordx4 v23, s[20:23], s68 offen offset:3072  lds
    s_add_u32 s68, s68, 65536
    s_and_b32 s68, s68, 524287
    s_mov_b32 s75, 0
L_chk_K2:
    s_waitcnt lgkmcnt(0)
    s_sub_u32 s36, s36, s32
    s_cmp_eq_u32 s36, 32
    s_cbranch_scc1 L_ok_K2
    s_add_u32 s75, s75, 1
    s_cmp_gt_u32 s75, 40000
    s_cbranch_scc1 L_ok_K2
    s_sleep 1
    s_mov_b32 s36, 0
    s_atomic_add s36, s[58:59], s94 glc
    s_branch L_chk_K2
L_ok_K2:
    s_waitcnt vmcnt(36)
    s_barrier
L_ljoin:
    s_waitcnt vmcnt(8)
    s_barrier
    s_add_u32 m0, s72, 131072
    s_nop 0
    buffer_load_dwordx4 v20, s[20:23], s68 offen offset:0  lds
    buffer_load_dwordx4 v21, s[20:23], s68 offen offset:1024  lds
    buffer_load_dwordx4 v22, s[20:23], s68 offen offset:2048  lds
    buffer_load_dwordx4 v23, s[20:23], s68 offen offset:3072  lds
    s_add_u32 s68, s68, 65536
    s_and_b32 s68, s68, 524287
    s_add_u32 m0, s72, 139264
    s_nop 0
    buffer_load_dwordx4 v20, s[20:23], s68 offen offset:0  lds
    buffer_load_dwordx4 v21, s[20:23], s68 offen offset:1024  lds
    buffer_load_dwordx4 v22, s[20:23], s68 offen offset:2048  lds
    buffer_load_dwordx4 v23, s[20:23], s68 offen offset:3072  lds
    s_add_u32 s68, s68, 65536
    s_and_b32 s68, s68, 524287
    s_add_u32 m0, s72, 147456
    s_nop 0
    buffer_load_dwordx4 v20, s[20:23], s68 offen offset:0  lds
    buffer_load_dwordx4 v21, s[20:23], s68 offen offset:1024  lds
    buffer_load_dwordx4 v22, s[20:23], s68 offen offset:2048  lds
    buffer_load_dwordx4 v23, s[20:23], s68 offen offset:3072  lds
    s_add_u32 s68, s68, 65536
    s_and_b32 s68, s68, 524287
    s_add_u32 m0, s72, 0
    s_nop 0
    buffer_load_dwordx4 v20, s[20:23], s68 offen offset:0  lds
    buffer_load_dwordx4 v21, s[20:23], s68 offen offset:1024  lds
    buffer_load_dwordx4 v22, s[20:23], s68 offen offset:2048  lds
    buffer_load_dwordx4 v23, s[20:23], s68 offen offset:3072  lds
    s_add_u32 s68, s68, 65536
    s_and_b32 s68, s68, 524287
    s_add_u32 m0, s72, 8192
    s_nop 0
    buffer_load_dwordx4 v20, s[20:23], s68 offen offset:0  lds
    buffer_load_dwordx4 v21, s[20:23], s68 offen offset:1024  lds
    buffer_load_dwordx4 v22, s[20:23], s68 offen offset:2048  lds
    buffer_load_dwordx4 v23, s[20:23], s68 offen offset:3072  lds
    s_add_u32 s68, s68, 65536
    s_and_b32 s68, s68, 524287
    s_waitcnt vmcnt(28)
    s_barrier
    s_add_u32 m0, s72, 16384
    s_nop 0
    buffer_load_dwordx4 v20, s[20:23], s68 offen offset:0  lds
    buffer_load_dwordx4 v21, s[20:23], s68 offen offset:1024  lds
    buffer_load_dwordx4 v22, s[20:23], s68 offen offset:2048  lds
    buffer_load_dwordx4 v23, s[20:23], s68 offen offset:3072  lds
    s_add_u32 s68, s68, 65536
    s_and_b32 s68, s68, 524287
    s_add_u32 m0, s72, 24576
    s_nop 0
    buffer_load_dwordx4 v24, s[24:27], s70 offen offset:0  lds
    buffer_load_dwordx4 v25, s[24:27], s70 offen offset:1024  lds
    buffer_load_dwordx4 v26, s[24:27], s70 offen offset:2048  lds
    buffer_load_dwordx4 v27, s[24:27], s70 offen offset:3072  lds
    s_add_u32 s70, s70, 262144
    s_cmp_eq_u32 s70, 5505024
    s_cselect_b32 s70, 0, s70
    s_add_u32 m0, s72, 32768
    s_nop 0
    buffer_load_dwordx4 v24, s[24:27], s70 offen offset:0  lds
    buffer_load_dwordx4 v25, s[24:27], s70 offen offset:1024  lds
    buffer_load_dwordx4 v26, s[24:27], s70 offen offset:2048  lds
    buffer_load_dwordx4 v27, s[24:27], s70 offen offset:3072  lds
    s_add_u32 s70, s70, 262144
    s_cmp_eq_u32 s70, 5505024
    s_cselect_b32 s70, 0, s70
    s_add_u32 m0, s72, 40960
    s_nop 0
    buffer_load_dwordx4 v24, s[24:27], s70 offen offset:0  lds
    buffer_load_dwordx4 v25, s[24:27], s70 offen offset:1024  lds
    buffer_load_dwordx4 v26, s[24:27], s70 offen offset:2048  lds
    buffer_load_dwordx4 v27, s[24:27], s70 offen offset:3072  lds
    s_add_u32 s70, s70, 262144
    s_cmp_eq_u32 s70, 5505024
    s_cselect_b32 s70, 0, s70
    s_mov_b32 s36, 0
    s_atomic_add s36, s[58:59], s92 glc
    s_mov_b32 s75, 0
L_chk_F2A:
    s_waitcnt lgkmcnt(0)
    s_sub_u32 s36, s36, s32
    s_cmp_eq_u32 s36, 32
    s_cbranch_scc1 L_ok_F2A
    s_add_u32 s75, s75, 1
    s_cmp_gt_u32 s75, 40000
    s_cbranch_scc1 L_ok_F2A
    s_sleep 1
    s_mov_b32 s36, 0
    s_atomic_add s36, s[58:59], s92 glc
    s_branch L_chk_F2A
L_ok_F2A:
    s_add_u32 m0, s72, 49152
    s_nop 0
    buffer_load_dwordx4 v29, s[4:7], s69 offen offset:0 sc1 lds
    buffer_load_dwordx4 v29, s[4:7], s69 offen offset:1024 sc1 lds
    buffer_load_dwordx4 v29, s[4:7], s69 offen offset:2048 sc1 lds
    buffer_load_dwordx4 v29, s[4:7], s69 offen offset:3072 sc1 lds
    s_add_u32 s69, s69, 8192
    s_and_b32 s69, s69, 65535
    s_add_u32 m0, s72, 57344
    s_nop 0
    buffer_load_dwordx4 v29, s[4:7], s69 offen offset:0 sc1 lds
    buffer_load_dwordx4 v29, s[4:7], s69 offen offset:1024 sc1 lds
    buffer_load_dwordx4 v29, s[4:7], s69 offen offset:2048 sc1 lds
    buffer_load_dwordx4 v29, s[4:7], s69 offen offset:3072 sc1 lds
    s_add_u32 s69, s69, 8192
    s_and_b32 s69, s69, 65535
    s_add_u32 m0, s72, 65536
    s_nop 0
    buffer_load_dwordx4 v29, s[4:7], s69 offen offset:0 sc1 lds
    buffer_load_dwordx4 v29, s[4:7], s69 offen offset:1024 sc1 lds
    buffer_load_dwordx4 v29, s[4:7], s69 offen offset:2048 sc1 lds
    buffer_load_dwordx4 v29, s[4:7], s69 offen offset:3072 sc1 lds
    s_add_u32 s69, s69, 8192
    s_and_b32 s69, s69, 65535
    s_add_u32 m0, s72, 73728
    s_nop 0
    buffer_load_dwordx4 v29, s[4:7], s69 offen offset:0 sc1 lds
    buffer_load_dwordx4 v29, s[4:7], s69 offen offset:1024 sc1 lds
    buffer_load_dwordx4 v29, s[4:7], s69 offen offset:2048 sc1 lds
    buffer_load_dwordx4 v29, s[4:7], s69 offen offset:3072 sc1 lds
    s_add_u32 s69, s69, 8192
    s_and_b32 s69, s69, 65535
    s_add_u32 m0, s72, 81920
    s_nop 0
    buffer_load_dwordx4 v29, s[4:7], s69 offen offset:0 sc1 lds
    buffer_load_dwordx4 v29, s[4:7], s69 offen offset:1024 sc1 lds
    buffer_load_dwordx4 v29, s[4:7], s69 offen offset:2048 sc1 lds
    buffer_load_dwordx4 v29, s[4:7], s69 offen offset:3072 sc1 lds
    s_add_u32 s69, s69, 8192
    s_and_b32 s69, s69, 65535
    s_add_u32 m0, s72, 90112
    s_nop 0
    buffer_load_dwordx4 v29, s[4:7], s69 offen offset:0 sc1 lds
    buffer_load_dwordx4 v29, s[4:7], s69 offen offset:1024 sc1 lds
    buffer_load_dwordx4 v29, s[4:7], s69 offen offset:2048 sc1 lds
    buffer_load_dwordx4 v29, s[4:7], s69 offen offset:3072 sc1 lds
    s_add_u32 s69, s69, 8192
    s_and_b32 s69, s69, 65535
    s_add_u32 m0, s72, 98304
    s_nop 0
    buffer_load_dwordx4 v29, s[4:7], s69 offen offset:0 sc1 lds
    buffer_load_dwordx4 v29, s[4:7], s69 offen offset:1024 sc1 lds
    buffer_load_dwordx4 v29, s[4:7], s69 offen offset:2048 sc1 lds
    buffer_load_dwordx4 v29, s[4:7], s69 offen offset:3072 sc1 lds
    s_add_u32 s69, s69, 8192
    s_and_b32 s69, s69, 65535
    s_add_u32 m0, s72, 106496
    s_nop 0
    buffer_load_dwordx4 v29, s[4:7], s69 offen offset:0 sc1 lds
    buffer_load_dwordx4 v29, s[4:7], s69 offen offset:1024 sc1 lds
    buffer_load_dwordx4 v29, s[4:7], s69 offen offset:2048 sc1 lds
    buffer_load_dwordx4 v29, s[4:7], s69 offen offset:3072 sc1 lds
    s_add_u32 s69, s69, 8192
    s_and_b32 s69, s69, 65535
    s_waitcnt vmcnt(28)
    s_barrier
    s_waitcnt vmcnt(24)
    s_barrier
    s_waitcnt vmcnt(20)
    s_barrier
    s_add_u32 m0, s72, 114688
    s_nop 0
    buffer_load_dwordx4 v24, s[24:27], s70 offen offset:0  lds
    buffer_load_dwordx4 v25, s[24:27], s70 offen offset:1024  lds
    buffer_load_dwordx4 v26, s[24:27], s70 offen offset:2048  lds
    buffer_load_dwordx4 v27, s[24:27], s70 offen offset:3072  lds
    s_add_u32 s70, s70, 262144
    s_cmp_eq_u32 s70, 5505024
    s_cselect_b32 s70, 0, s70
    s_add_u32 m0, s72, 49152
    s_nop 0
    buffer_load_dwordx4 v24, s[24:27], s70 offen offset:0  lds
    buffer_load_dwordx4 v25, s[24:27], s70 offen offset:1024  lds
    buffer_load_dwordx4 v26, s[24:27], s70 offen offset:2048  lds
    buffer_load_dwordx4 v27, s[24:27], s70 offen offset:3072  lds
    s_add_u32 s70, s70, 262144
    s_cmp_eq_u32 s70, 5505024
    s_cselect_b32 s70, 0, s70
    s_waitcnt vmcnt(24)
    s_barrier
    s_add_u32 m0, s72, 122880
    s_nop 0
    buffer_load_dwordx4 v24, s[24:27], s70 offen offset:0  lds
    buffer_load_dwordx4 v25, s[24:27], s70 offen offset:1024  lds
    buffer_load_dwordx4 v26, s[24:27], s70 offen offset:2048  lds
    buffer_load_dwordx4 v27, s[24:27], s70 offen offset:3072  lds
    s_add_u32 s70, s70, 262144
    s_cmp_eq_u32 s70, 5505024
    s_cselect_b32 s70, 0, s70
    s_waitcnt vmcnt(24)
    s_barrier
    s_add_u32 m0, s72, 57344
    s_nop 0
    buffer_load_dwordx4 v24, s[24:27], s70 offen offset:0  lds
    buffer_load_dwordx4 v25, s[24:27], s70 offen offset:1024  lds
    buffer_load_dwordx4 v26, s[24:27], s70 offen offset:2048  lds
    buffer_load_dwordx4 v27, s[24:27], s70 offen offset:3072  lds
    s_add_u32 s70, s70, 262144
    s_cmp_eq_u32 s70, 5505024
    s_cselect_b32 s70, 0, s70
    s_waitcnt vmcnt(24)
    s_barrier
    s_add_u32 m0, s72, 131072
    s_nop 0
    buffer_load_dwordx4 v24, s[24:27], s70 offen offset:0  lds
    buffer_load_dwordx4 v25, s[24:27], s70 offen offset:1024  lds
    buffer_load_dwordx4 v26, s[24:27], s70 offen offset:2048  lds
    buffer_load_dwordx4 v27, s[24:27], s70 offen offset:3072  lds
    s_add_u32 s70, s70, 262144
    s_cmp_eq_u32 s70, 5505024
    s_cselect_b32 s70, 0, s70
    s_mov_b64 s[36:37], 0
    s_mov_b64 s[38:39], 0
    s_atomic_add s36, s[44:45], 0 glc
    s_atomic_add s37, s[44:45], 256 glc
    s_atomic_add s38, s[44:45], 512 glc
    s_atomic_add s39, s[44:45], 768 glc
    s_add_u32 m0, s72, 65536
    s_nop 0
    buffer_load_dwordx4 v24, s[24:27], s70 offen offset:0  lds
    buffer_load_dwordx4 v25, s[24:27], s70 offen offset:1024  lds
    buffer_load_dwordx4 v26, s[24:27], s70 offen offset:2048  lds
    buffer_load_dwordx4 v27, s[24:27], s70 offen offset:3072  lds
    s_add_u32 s70, s70, 262144
    s_cmp_eq_u32 s70, 5505024
    s_cselect_b32 s70, 0, s70
    s_waitcnt vmcnt(28)
    s_barrier
    s_add_u32 m0, s72, 139264
    s_nop 0
    buffer_load_dwordx4 v24, s[24:27], s70 offen offset:0  lds
    buffer_load_dwordx4 v25, s[24:27], s70 offen offset:1024  lds
    buffer_load_dwordx4 v26, s[24:27], s70 offen offset:2048  lds
    buffer_load_dwordx4 v27, s[24:27], s70 offen offset:3072  lds
    s_add_u32 s70, s70, 262144
    s_cmp_eq_u32 s70, 5505024
    s_cselect_b32 s70, 0, s70
    s_waitcnt vmcnt(28)
    s_barrier
    s_add_u32 m0, s72, 73728
    s_nop 0
    buffer_load_dwordx4 v24, s[24:27], s70 offen offset:0  lds
    buffer_load_dwordx4 v25, s[24:27], s70 offen offset:1024  lds
    buffer_load_dwordx4 v26, s[24:27], s70 offen offset:2048  lds
    buffer_load_dwordx4 v27, s[24:27], s70 offen offset:3072  lds
    s_add_u32 s70, s70, 262144
    s_cmp_eq_u32 s70, 5505024
    s_cselect_b32 s70, 0, s70
    s_add_u32 m0, s72, 147456
    s_nop 0
    buffer_load_dwordx4 v24, s[24:27], s70 offen offset:0  lds
    buffer_load_dwordx4 v25, s[24:27], s70 offen offset:1024  lds
    buffer_load_dwordx4 v26, s[24:27], s70 offen offset:2048  lds
    buffer_load_dwordx4 v27, s[24:27], s70 offen offset:3072  lds
    s_add_u32 s70, s70, 262144
    s_cmp_eq_u32 s70, 5505024
    s_cselect_b32 s70, 0, s70
    s_mov_b32 s75, 0
    s_add_u32 s40, s32, 22
    s_mov_b32 s41, s40
L_chk_F2B:
    s_waitcnt lgkmcnt(0)
    s_xor_b64 s[36:37], s[36:37], s[40:41]
    s_xor_b64 s[38:39], s[38:39], s[40:41]
    s_or_b64 s[36:37], s[36:37], s[38:39]
    s_cbranch_scc0 L_ok_F2B
    s_add_u32 s75, s75, 1
    s_cmp_gt_u32 s75, 40000
    s_cbranch_scc1 L_ok_F2B
    s_mov_b64 s[36:37], 0
    s_mov_b64 s[38:39], 0
    s_atomic_add s36, s[44:45], 0 glc
    s_atomic_add s37, s[44:45], 256 glc
    s_atomic_add s38, s[44:45], 512 glc
    s_atomic_add s39, s[44:45], 768 glc
    s_branch L_chk_F2B
L_ok_F2B:
    s_add_u32 m0, s72, 81920
    s_mov_b32 s74, 172032
    buffer_load_dwordx4 v30, s[4:7], s74 offen offset:0 sc1 lds
    buffer_load_dwordx4 v30, s[4:7], s74 offen offset:1024 sc1 lds
    buffer_load_dwordx4 v30, s[4:7], s74 offen offset:2048 sc1 lds
    buffer_load_dwordx4 v30, s[4:7], s74 offen offset:3072 sc1 lds
    s_add_u32 m0, s72, 0
    s_nop 0
    buffer_load_dwordx4 v30, s[4:7], s71 offen offset:0 sc1 lds
    buffer_load_dwordx4 v30, s[4:7], s71 offen offset:1024 sc1 lds
    buffer_load_dwordx4 v30, s[4:7], s71 offen offset:2048 sc1 lds
    buffer_load_dwordx4 v30, s[4:7], s71 offen offset:3072 sc1 lds
    s_add_u32 s71, s71, 8192
    s_cmp_eq_u32 s71, 172032
    s_cselect_b32 s71, 0, s71
    s_add_u32 m0, s72, 90112
    s_nop 0
    buffer_load_dwordx4 v30, s[4:7], s71 offen offset:0 sc1 lds
    buffer_load_dwordx4 v30, s[4:7], s71 offen offset:1024 sc1 lds
    buffer_load_dwordx4 v30, s[4:7], s71 offen offset:2048 sc1 lds
    buffer_load_dwordx4 v30, s[4:7], s71 offen offset:3072 sc1 lds
    s_add_u32 s71, s71, 8192
    s_cmp_eq_u32 s71, 172032
    s_cselect_b32 s71, 0, s71
    s_waitcnt vmcnt(8)
    s_barrier
    s_add_u32 m0, s72, 8192
    s_nop 0
    buffer_load_dwordx4 v30, s[4:7], s71 offen offset:0 sc1 lds
    buffer_load_dwordx4 v30, s[4:7], s71 offen offset:1024 sc1 lds
    buffer_load_dwordx4 v30, s[4:7], s71 offen offset:2048 sc1 lds
    buffer_load_dwordx4 v30, s[4:7], s71 offen offset:3072 sc1 lds
    s_add_u32 s71, s71, 8192
    s_cmp_eq_u32 s71, 172032
    s_cselect_b32 s71, 0, s71
    s_add_u32 m0, s72, 98304
    s_nop 0
    buffer_load_dwordx4 v30, s[4:7], s71 offen offset:0 sc1 lds
    buffer_load_dwordx4 v30, s[4:7], s71 offen offset:1024 sc1 lds
    buffer_load_dwordx4 v30, s[4:7], s71 offen offset:2048 sc1 lds
    buffer_load_dwordx4 v30, s[4:7], s71 offen offset:3072 sc1 lds
    s_add_u32 s71, s71, 8192
    s_cmp_eq_u32 s71, 172032
    s_cselect_b32 s71, 0, s71
    s_waitcnt vmcnt(12)
    s_barrier
    s_add_u32 m0, s72, 16384
    s_nop 0
    buffer_load_dwordx4 v30, s[4:7], s71 offen offset:0 sc1 lds
    buffer_load_dwordx4 v30, s[4:7], s71 offen offset:1024 sc1 lds
    buffer_load_dwordx4 v30, s[4:7], s71 offen offset:2048 sc1 lds
    buffer_load_dwordx4 v30, s[4:7], s71 offen offset:3072 sc1 lds
    s_add_u32 s71, s71, 8192
    s_cmp_eq_u32 s71, 172032
    s_cselect_b32 s71, 0, s71
    s_add_u32 m0, s72, 106496
    s_nop 0
    buffer_load_dwordx4 v30, s[4:7], s71 offen offset:0 sc1 lds
    buffer_load_dwordx4 v30, s[4:7], s71 offen offset:1024 sc1 lds
    buffer_load_dwordx4 v30, s[4:7], s71 offen offset:2048 sc1 lds
    buffer_load_dwordx4 v30, s[4:7], s71 offen offset:3072 sc1 lds
    s_add_u32 s71, s71, 8192
    s_cmp_eq_u32 s71, 172032
    s_cselect_b32 s71, 0, s71
    s_waitcnt vmcnt(16)
    s_barrier
    s_add_u32 m0, s72, 81920
    s_nop 0
    buffer_load_dwordx4 v30, s[4:7], s71 offen offset:0 sc1 lds
    buffer_load_dwordx4 v30, s[4:7], s71 offen offset:1024 sc1 lds
    buffer_load_dwordx4 v30, s[4:7], s71 offen offset:2048 sc1 lds
    buffer_load_dwordx4 v30, s[4:7], s71 offen offset:3072 sc1 lds
    s_add_u32 s71, s71, 8192
    s_cmp_eq_u32 s71, 172032
    s_cselect_b32 s71, 0, s71
    s_waitcnt vmcnt(16)
    s_barrier
    s_add_u32 m0, s72, 0
    s_nop 0
    buffer_load_dwordx4 v30, s[4:7], s71 offen offset:0 sc1 lds
    buffer_load_dwordx4 v30, s[4:7], s71 offen offset:1024 sc1 lds
    buffer_load_dwordx4 v30, s[4:7], s71 offen offset:2048 sc1 lds
    buffer_load_dwordx4 v30, s[4:7], s71 offen offset:3072 sc1 lds
    s_add_u32 s71, s71, 8192
    s_cmp_eq_u32 s71, 172032
    s_cselect_b32 s71, 0, s71
    s_waitcnt vmcnt(16)
    s_barrier
    s_add_u32 m0, s72, 90112
    s_nop 0
    buffer_load_dwordx4 v30, s[4:7], s71 offen offset:0 sc1 lds
    buffer_load_dwordx4 v30, s[4:7], s71 offen offset:1024 sc1 lds
    buffer_load_dwordx4 v30, s[4:7], s71 offen offset:2048 sc1 lds
    buffer_load_dwordx4 v30, s[4:7], s71 offen offset:3072 sc1 lds
    s_add_u32 s71, s71, 8192
    s_cmp_eq_u32 s71, 172032
    s_cselect_b32 s71, 0, s71
    s_waitcnt vmcnt(16)
    s_barrier
    s_add_u32 m0, s72, 8192
    s_nop 0
    buffer_load_dwordx4 v30, s[4:7], s71 offen offset:0 sc1 lds
    buffer_load_dwordx4 v30, s[4:7], s71 offen offset:1024 sc1 lds
    buffer_load_dwordx4 v30, s[4:7], s71 offen offset:2048 sc1 lds
    buffer_load_dwordx4 v30, s[4:7], s71 offen offset:3072 sc1 lds
    s_add_u32 s71, s71, 8192
    s_cmp_eq_u32 s71, 172032
    s_cselect_b32 s71, 0, s71
    s_waitcnt vmcnt(16)
    s_barrier
    s_add_u32 m0, s72, 98304
    s_nop 0
    buffer_load_dwordx4 v30, s[4:7], s71 offen offset:0 sc1 lds
    buffer_load_dwordx4 v30, s[4:7], s71 offen offset:1024 sc1 lds
    buffer_load_dwordx4 v30, s[4:7], s71 offen offset:2048 sc1 lds
    buffer_load_dwordx4 v30, s[4:7], s71 offen offset:3072 sc1 lds
    s_add_u32 s71, s71, 8192
    s_cmp_eq_u32 s71, 172032
    s_cselect_b32 s71, 0, s71
    s_waitcnt vmcnt(16)
    s_barrier
    s_add_u32 m0, s72, 16384
    s_nop 0
    buffer_load_dwordx4 v30, s[4:7], s71 offen offset:0 sc1 lds
    buffer_load_dwordx4 v30, s[4:7], s71 offen offset:1024 sc1 lds
    buffer_load_dwordx4 v30, s[4:7], s71 offen offset:2048 sc1 lds
    buffer_load_dwordx4 v30, s[4:7], s71 offen offset:3072 sc1 lds
    s_add_u32 s71, s71, 8192
    s_cmp_eq_u32 s71, 172032
    s_cselect_b32 s71, 0, s71
    s_waitcnt vmcnt(16)
    s_barrier
    s_add_u32 m0, s72, 106496
    s_nop 0
    buffer_load_dwordx4 v30, s[4:7], s71 offen offset:0 sc1 lds
    buffer_load_dwordx4 v30, s[4:7], s71 offen offset:1024 sc1 lds
    buffer_load_dwordx4 v30, s[4:7], s71 offen offset:2048 sc1 lds
    buffer_load_dwordx4 v30, s[4:7], s71 offen offset:3072 sc1 lds
    s_add_u32 s71, s71, 8192
    s_cmp_eq_u32 s71, 172032
    s_cselect_b32 s71, 0, s71
    s_waitcnt vmcnt(16)
    s_barrier
    s_add_u32 m0, s72, 24576
    s_nop 0
    buffer_load_dwordx4 v30, s[4:7], s71 offen offset:0 sc1 lds
    buffer_load_dwordx4 v30, s[4:7], s71 offen offset:1024 sc1 lds
    buffer_load_dwordx4 v30, s[4:7], s71 offen offset:2048 sc1 lds
    buffer_load_dwordx4 v30, s[4:7], s71 offen offset:3072 sc1 lds
    s_add_u32 s71, s71, 8192
    s_cmp_eq_u32 s71, 172032
    s_cselect_b32 s71, 0, s71
    s_add_u32 m0, s72, 81920
    s_nop 0
    buffer_load_dwordx4 v30, s[4:7], s71 offen offset:0 sc1 lds
    buffer_load_dwordx4 v30, s[4:7], s71 offen offset:1024 sc1 lds
    buffer_load_dwordx4 v30, s[4:7], s71 offen offset:2048 sc1 lds
    buffer_load_dwordx4 v30, s[4:7], s71 offen offset:3072 sc1 lds
    s_add_u32 s71, s71, 8192
    s_cmp_eq_u32 s71, 172032
    s_cselect_b32 s71, 0, s71
    s_waitcnt vmcnt(20)
    s_barrier
    s_add_u32 m0, s72, 32768
    s_nop 0
    buffer_load_dwordx4 v30, s[4:7], s71 offen offset:0 sc1 lds
    buffer_load_dwordx4 v30, s[4:7], s71 offen offset:1024 sc1 lds
    buffer_load_dwordx4 v30, s[4:7], s71 offen offset:2048 sc1 lds
    buffer_load_dwordx4 v30, s[4:7], s71 offen offset:3072 sc1 lds
    s_add_u32 s71, s71, 8192
    s_cmp_eq_u32 s71, 172032
    s_cselect_b32 s71, 0, s71
    s_waitcnt vmcnt(20)
    s_barrier
    s_add_u32 m0, s72, 0
    s_nop 0
    buffer_load_dwordx4 v30, s[4:7], s71 offen offset:0 sc1 lds
    buffer_load_dwordx4 v30, s[4:7], s71 offen offset:1024 sc1 lds
    buffer_load_dwordx4 v30, s[4:7], s71 offen offset:2048 sc1 lds
    buffer_load_dwordx4 v30, s[4:7], s71 offen offset:3072 sc1 lds
    s_add_u32 s71, s71, 8192
    s_cmp_eq_u32 s71, 172032
    s_cselect_b32 s71, 0, s71
    s_waitcnt vmcnt(20)
    s_barrier
    s_add_u32 m0, s72, 40960
    s_nop 0
    buffer_load_dwordx4 v30, s[4:7], s71 offen offset:0 sc1 lds
    buffer_load_dwordx4 v30, s[4:7], s71 offen offset:1024 sc1 lds
    buffer_load_dwordx4 v30, s[4:7], s71 offen offset:2048 sc1 lds
    buffer_load_dwordx4 v30, s[4:7], s71 offen offset:3072 sc1 lds
    s_add_u32 s71, s71, 8192
    s_cmp_eq_u32 s71, 172032
    s_cselect_b32 s71, 0, s71
    s_waitcnt vmcnt(20)
    s_barrier
    s_add_u32 m0, s72, 90112
    s_nop 0
    buffer_load_dwordx4 v24, s[24:27], s70 offen offset:0  lds
    buffer_load_dwordx4 v25, s[24:27], s70 offen offset:1024  lds
    buffer_load_dwordx4 v26, s[24:27], s70 offen offset:2048  lds
    buffer_load_dwordx4 v27, s[24:27], s70 offen offset:3072  lds
    s_add_u32 s70, s70, 262144
    s_cmp_eq_u32 s70, 5505024
    s_cselect_b32 s70, 0, s70
    s_waitcnt vmcnt(20)
    s_barrier
    s_add_u32 m0, s72, 114688
    s_nop 0
    buffer_load_dwordx4 v30, s[4:7], s71 offen offset:0 sc1 lds
    buffer_load_dwordx4 v30, s[4:7], s71 offen offset:1024 sc1 lds
    buffer_load_dwordx4 v30, s[4:7], s71 offen offset:2048 sc1 lds
    buffer_load_dwordx4 v30, s[4:7], s71 offen offset:3072 sc1 lds
    s_add_u32 s71, s71, 8192
    s_cmp_eq_u32 s71, 172032
    s_cselect_b32 s71, 0, s71
    s_waitcnt vmcnt(20)
    s_barrier
    s_add_u32 m0, s72, 8192
    s_nop 0
    buffer_load_dwordx4 v24, s[24:27], s70 offen offset:0  lds
    buffer_load_dwordx4 v25, s[24:27], s70 offen offset:1024  lds
    buffer_load_dwordx4 v26, s[24:27], s70 offen offset:2048  lds
    buffer_load_dwordx4 v27, s[24:27], s70 offen offset:3072  lds
    s_add_u32 s70, s70, 262144
    s_cmp_eq_u32 s70, 5505024
    s_cselect_b32 s70, 0, s70
    s_waitcnt vmcnt(20)
    s_barrier
    s_add_u32 m0, s72, 49152
    s_nop 0
    buffer_load_dwordx4 v30, s[4:7], s71 offen offset:0 sc1 lds
    buffer_load_dwordx4 v30, s[4:7], s71 offen offset:1024 sc1 lds
    buffer_load_dwordx4 v30, s[4:7], s71 offen offset:2048 sc1 lds
    buffer_load_dwordx4 v30, s[4:7], s71 offen offset:3072 sc1 lds
    s_add_u32 s71, s71, 8192
    s_cmp_eq_u32 s71, 172032
    s_cselect_b32 s71, 0, s71
    s_waitcnt vmcnt(20)
    s_barrier
    s_add_u32 m0, s72, 98304
    s_nop 0
    buffer_load_dwordx4 v24, s[24:27], s70 offen offset:0  lds
    buffer_load_dwordx4 v25, s[24:27], s70 offen offset:1024  lds
    buffer_load_dwordx4 v26, s[24:27], s70 offen offset:2048  lds
    buffer_load_dwordx4 v27, s[24:27], s70 offen offset:3072  lds
    s_add_u32 s70, s70, 262144
    s_cmp_eq_u32 s70, 5505024
    s_cselect_b32 s70, 0, s70
    s_waitcnt vmcnt(20)
    s_barrier
    s_add_u32 m0, s72, 122880
    s_nop 0
    buffer_load_dwordx4 v30, s[4:7], s71 offen offset:0 sc1 lds
    buffer_load_dwordx4 v30, s[4:7], s71 offen offset:1024 sc1 lds
    buffer_load_dwordx4 v30, s[4:7], s71 offen offset:2048 sc1 lds
    buffer_load_dwordx4 v30, s[4:7], s71 offen offset:3072 sc1 lds
    s_add_u32 s71, s71, 8192
    s_cmp_eq_u32 s71, 172032
    s_cselect_b32 s71, 0, s71
    s_waitcnt vmcnt(16)
    s_barrier
    s_waitcnt vmcnt(8)
    s_barrier
    s_waitcnt vmcnt(0)
    s_barrier
L_exit:
    s_endpgm
L_lhelper:
    s_lshr_b32 s57, s2, 3
    s_cmp_ge_u32 s57, 24
    s_cselect_b32 s18, s22, 0
    s_cselect_b32 s98, s26, 0
    s_mov_b64 s[16:17], s[20:21]
    s_mov_b64 s[96:97], s[24:25]
    s_lshl_b32 s56, s52, 1
    s_add_u32 s56, s56, s55
    v_bfe_u32 v5, v1, 2, 3
    v_lshlrev_b32 v5, 10, v5
    v_and_b32 v6, 3, v1
    v_lshl_add_u32 v6, v6, 7, v5
    s_and_b32 s60, s33, 1
    s_lshl_b32 s60, s60, 9
    s_lshr_b32 s61, s33, 1
    s_lshl_b32 s61, s61, 17
    s_add_u32 s60, s60, s61
    s_lshl_b32 s61, s56, 13
    s_add_u32 s62, s60, s61
    v_lshrrev_b32 v5, 3, v1
    v_lshlrev_b32 v5, 12, v5
    v_lshl_add_u32 v5, v3, 7, v5
    s_lshr_b32 s60, s33, 1
    s_lshl_b32 s60, s60, 10
    v_add_u32 v5, s60, v5
    s_and_b32 s60, s33, 1
    s_lshl_b32 s63, s56, 1
    s_add_u32 s63, s63, s60
    s_add_u32 s60, s63, 168
    s_sub_u32 s61, s63, 4
    s_cmp_ge_u32 s63, 4
    s_cselect_b32 s60, s61, s60
    s_lshl_b32 s60, s60, 15
    buffer_load_dword v48, v5, s[96:99], s60 offen
    s_waitcnt vmcnt(2)
    s_barrier
    s_waitcnt vmcnt(1)
    s_barrier
    s_waitcnt vmcnt(1)
    s_add_u32 s60, s63, 28
    s_lshl_b32 s60, s60, 15
    buffer_load_dword v48, v5, s[96:99], s60 offen
    buffer_load_dword v48, v6, s[16:19], s62 offen
    s_waitcnt vmcnt(1)
    s_add_u32 s60, s63, 60
    s_lshl_b32 s60, s60, 15
    buffer_load_dword v48, v5, s[96:99], s60 offen
    s_waitcnt vmcnt(1)
    s_add_u32 s60, s63, 92
    s_lshl_b32 s60, s60, 15
    buffer_load_dword v48, v5, s[96:99], s60 offen
    s_waitcnt vmcnt(1)
    s_add_u32 s60, s63, 124
    s_lshl_b32 s60, s60, 15
    buffer_load_dword v48, v5, s[96:99], s60 offen
    s_waitcnt vmcnt(1)
    s_add_u32 s60, s63, 156
    s_lshl_b32 s60, s60, 15
    buffer_load_dword v48, v5, s[96:99], s60 offen
    s_barrier
    s_add_u32 m0, s72, 57344
    s_mov_b32 s74, 5505024
    buffer_load_dwordx4 v24, s[24:27], s74 offen offset:0  lds
    buffer_load_dwordx4 v25, s[24:27], s74 offen offset:1024  lds
    buffer_load_dwordx4 v26, s[24:27], s74 offen offset:2048  lds
    buffer_load_dwordx4 v27, s[24:27], s74 offen offset:3072  lds
    s_add_u32 m0, s72, 65536
    s_nop 0
    buffer_load_dwordx4 v24, s[24:27], s70 offen offset:0  lds
    buffer_load_dwordx4 v25, s[24:27], s70 offen offset:1024  lds
    buffer_load_dwordx4 v26, s[24:27], s70 offen offset:2048  lds
    buffer_load_dwordx4 v27, s[24:27], s70 offen offset:3072  lds
    s_add_u32 s70, s70, 262144
    s_cmp_eq_u32 s70, 5505024
    s_cselect_b32 s70, 0, s70
    s_add_u32 m0, s72, 73728
    s_nop 0
    buffer_load_dwordx4 v24, s[24:27], s70 offen offset:0  lds
    buffer_load_dwordx4 v25, s[24:27], s70 offen offset:1024  lds
    buffer_load_dwordx4 v26, s[24:27], s70 offen offset:2048  lds
    buffer_load_dwordx4 v27, s[24:27], s70 offen offset:3072  lds
    s_add_u32 s70, s70, 262144
    s_cmp_eq_u32 s70, 5505024
    s_cselect_b32 s70, 0, s70
    s_add_u32 m0, s72, 81920
    s_nop 0
    buffer_load_dwordx4 v24, s[24:27], s70 offen offset:0  lds
    buffer_load_dwordx4 v25, s[24:27], s70 offen offset:1024  lds
    buffer_load_dwordx4 v26, s[24:27], s70 offen offset:2048  lds
    buffer_load_dwordx4 v27, s[24:27], s70 offen offset:3072  lds
    s_add_u32 s70, s70, 262144
    s_cmp_eq_u32 s70, 5505024
    s_cselect_b32 s70, 0, s70
    s_add_u32 m0, s72, 90112
    s_nop 0
    buffer_load_dwordx4 v24, s[24:27], s70 offen offset:0  lds
    buffer_load_dwordx4 v25, s[24:27], s70 offen offset:1024  lds
    buffer_load_dwordx4 v26, s[24:27], s70 offen offset:2048  lds
    buffer_load_dwordx4 v27, s[24:27], s70 offen offset:3072  lds
    s_add_u32 s70, s70, 262144
    s_cmp_eq_u32 s70, 5505024
    s_cselect_b32 s70, 0, s70
    s_add_u32 m0, s72, 98304
    s_nop 0
    buffer_load_dwordx4 v24, s[24:27], s70 offen offset:0  lds
    buffer_load_dwordx4 v25, s[24:27], s70 offen offset:1024  lds
    buffer_load_dwordx4 v26, s[24:27], s70 offen offset:2048  lds
    buffer_load_dwordx4 v27, s[24:27], s70 offen offset:3072  lds
    s_add_u32 s70, s70, 262144
    s_cmp_eq_u32 s70, 5505024
    s_cselect_b32 s70, 0, s70
    s_add_u32 m0, s72, 106496
    s_nop 0
    buffer_load_dwordx4 v24, s[24:27], s70 offen offset:0  lds
    buffer_load_dwordx4 v25, s[24:27], s70 offen offset:1024  lds
    buffer_load_dwordx4 v26, s[24:27], s70 offen offset:2048  lds
    buffer_load_dwordx4 v27, s[24:27], s70 offen offset:3072  lds
    s_add_u32 s70, s70, 262144
    s_cmp_eq_u32 s70, 5505024
    s_cselect_b32 s70, 0, s70
    s_add_u32 m0, s72, 114688
    s_nop 0
    buffer_load_dwordx4 v20, s[20:23], s68 offen offset:0  lds
    buffer_load_dwordx4 v21, s[20:23], s68 offen offset:1024  lds
    buffer_load_dwordx4 v22, s[20:23], s68 offen offset:2048  lds
    buffer_load_dwordx4 v23, s[20:23], s68 offen offset:3072  lds
    s_add_u32 s68, s68, 65536
    s_and_b32 s68, s68, 524287
    s_add_u32 m0, s72, 122880
    s_nop 0
    buffer_load_dwordx4 v20, s[20:23], s68 offen offset:0  lds
    buffer_load_dwordx4 v21, s[20:23], s68 offen offset:1024  lds
    buffer_load_dwordx4 v22, s[20:23], s68 offen offset:2048  lds
    buffer_load_dwordx4 v23, s[20:23], s68 offen offset:3072  lds
    s_add_u32 s68, s68, 65536
    s_and_b32 s68, s68, 524287
    s_branch L_ljoin
L_consumer:
    s_add_u32 s62, s62, s3
    s_lshr_b32 s3, s3, 1
    v_lshrrev_b32 v43, 5, v1
    s_lshr_b32 s60, s2, 3
    s_and_b32 s61, s33, 1
    s_mul_i32 s89, s61, 24
    s_add_u32 s89, s89, s60
    s_lshr_b32 s90, s33, 1
    s_lshl_b32 s61, s61, 2
    s_add_u32 s60, s60, s61
    s_cmp_lt_u32 s60, 24
    s_cselect_b32 s54, 1, 0
    s_lshr_b32 s53, s89, 2
    s_lshl_b32 s53, s53, 1
    s_and_b32 s61, s90, 1
    s_add_u32 s53, s53, s61
    s_and_b32 s88, s89, 3
    s_lshl_b32 s88, s88, 1
    s_lshr_b32 s61, s90, 1
    s_add_u32 s88, s88, s61
    s_add_u32 s73, s35, s34
    s_and_b32 s73, s73, 1
    s_mul_i32 s73, s73, 4
    s_mul_i32 s61, s33, 5
    s_lshr_b32 s61, s61, 1
    s_add_u32 s73, s73, s61
    s_and_b32 s73, s73, 7
    s_mov_b32 s6, 20971520
    s_mov_b32 s7, 0x20000
    s_mov_b32 s14, 2097152
    s_mov_b32 s15, 0x20000
    v_and_b32 v2, 15, v1
    v_lshrrev_b32 v3, 4, v1
    v_mov_b32 v16, 0x3f803f80
    v_mov_b32 v17, 0x3f803f80
    v_mov_b32 v18, 0x3f803f80
    v_mov_b32 v19, 0x3f803f80
    s_lshl_b32 s63, s62, 7
    s_add_u32 s63, s63, 2097152
    s_add_u32 s64, s63, 0x100000
    v_bfe_u32 v5, v1, 3, 2
    v_and_b32 v6, 7, v1
    v_lshlrev_b32 v6, 4, v6
    v_lshl_add_u32 v6, v5, 18, v6
    v_lshl_add_u32 v241, v43, 7, v6
    s_and_b32 s71, s3, 1
    s_lshr_b32 s72, s3, 1
    v_bfe_u32 v13, v1, 2, 2
    v_and_b32 v14, 3, v1
    v_lshlrev_b32 v14, 3, v14
    v_lshrrev_b32 v5, 1, v2
    v_xor_b32 v5, v5, v3
    v_lshlrev_b32 v5, 4, v5
    v_lshl_add_u32 v4, v2, 7, v5
    v_xor_b32 v7, 64, v4
    v_add_u32 v5, 0x10000, v4
    v_add_u32 v6, 0x20000, v4
    v_add_u32 v8, 0x10000, v7
    v_add_u32 v9, 0x20000, v7
    v_lshl_add_u32 v10, v3, 3, v13
    v_lshlrev_b32 v10, 7, v10
    v_and_b32 v11, 1, v3
    v_lshlrev_b32 v11, 1, v11
    v_lshrrev_b32 v12, 1, v13
    v_or_b32 v11, v11, v12
    v_xor_b32 v11, s3, v11
    v_lshl_add_u32 v10, v11, 5, v10
    v_add_u32 v10, v10, v14
    v_add_u32 v11, 0x10000, v10
    v_add_u32 v12, 0x20000, v10
    s_lshl_b32 s60, s72, 5
    v_add_u32 v36, s60, v42
    v_bfe_u32 v37, v36, 1, 3
    s_lshl_b32 s60, s71, 2
    v_xor_b32 v37, s60, v37
    v_lshlrev_b32 v37, 4, v37
    v_lshl_add_u32 v15, v36, 7, v37
    v_lshl_add_u32 v15, v43, 3, v15
    s_sub_u32 s73, s35, s73
    s_and_b32 s73, s73, 7
    s_mov_b64 s[4:5], s[58:59]
    s_mov_b64 s[12:13], s[56:57]
    s_waitcnt vmcnt(0)
    v_lshlrev_b32 v144, 16, v112
    v_and_b32 v145, 0xffff0000, v112
    v_lshlrev_b32 v146, 16, v113
    v_and_b32 v147, 0xffff0000, v113
    v_lshlrev_b32 v148, 16, v114
    v_and_b32 v149, 0xffff0000, v114
    v_lshlrev_b32 v150, 16, v115
    v_and_b32 v151, 0xffff0000, v115
    v_lshlrev_b32 v152, 16, v116
    v_and_b32 v153, 0xffff0000, v116
    v_lshlrev_b32 v154, 16, v117
    v_and_b32 v155, 0xffff0000, v117
    v_lshlrev_b32 v156, 16, v118
    v_and_b32 v157, 0xffff0000, v118
    v_lshlrev_b32 v158, 16, v119
    v_and_b32 v159, 0xffff0000, v119
    v_pk_add_f32 v[44:45], v[144:145], v[146:147]
    v_pk_add_f32 v[44:45], v[44:45], v[148:149]
    v_pk_add_f32 v[44:45], v[44:45], v[150:151]
    v_pk_add_f32 v[44:45], v[44:45], v[152:153]
    v_pk_add_f32 v[44:45], v[44:45], v[154:155]
    v_pk_add_f32 v[44:45], v[44:45], v[156:157]
    v_pk_add_f32 v[44:45], v[44:45], v[158:159]
    v_add_f32 v44, v44, v45
    s_nop 1
    v_add_f32_dpp v44, v44, v44 row_ror:8 row_mask:0xf bank_mask:0xf
    s_nop 1
    v_add_f32_dpp v44, v44, v44 row_ror:4 row_mask:0xf bank_mask:0xf
    s_nop 1
    v_add_f32_dpp v44, v44, v44 row_ror:2 row_mask:0xf bank_mask:0xf
    s_nop 1
    v_add_f32_dpp v44, v44, v44 row_ror:1 row_mask:0xf bank_mask:0xf
    v_mov_b32 v38, v44
    s_nop 1
    v_permlane16_swap_b32 v44, v38
    v_add_f32 v44, v44, v38
    v_mul_f32 v44, 0x3b000000, v44
    v_pk_add_f32 v[144:145], v[144:145], v[44:45] op_sel_hi:[1,0] neg_lo:[0,1] neg_hi:[0,1]
    v_pk_add_f32 v[146:147], v[146:147], v[44:45] op_sel_hi:[1,0] neg_lo:[0,1] neg_hi:[0,1]
    v_pk_add_f32 v[148:149], v[148:149], v[44:45] op_sel_hi:[1,0] neg_lo:[0,1] neg_hi:[0,1]
    v_pk_add_f32 v[150:151], v[150:151], v[44:45] op_sel_hi:[1,0] neg_lo:[0,1] neg_hi:[0,1]
    v_pk_add_f32 v[152:153], v[152:153], v[44:45] op_sel_hi:[1,0] neg_lo:[0,1] neg_hi:[0,1]
    v_pk_add_f32 v[154:155], v[154:155], v[44:45] op_sel_hi:[1,0] neg_lo:[0,1] neg_hi:[0,1]
    v_pk_add_f32 v[156:157], v[156:157], v[44:45] op_sel_hi:[1,0] neg_lo:[0,1] neg_hi:[0,1]
    v_pk_add_f32 v[158:159], v[158:159], v[44:45] op_sel_hi:[1,0] neg_lo:[0,1] neg_hi:[0,1]
    v_pk_mul_f32 v[36:37], v[144:145], v[144:145]
    v_pk_fma_f32 v[36:37], v[146:147], v[146:147], v[36:37]
    v_pk_fma_f32 v[36:37], v[148:149], v[148:149], v[36:37]
    v_pk_fma_f32 v[36:37], v[150:151], v[150:151], v[36:37]
    v_pk_fma_f32 v[36:37], v[152:153], v[152:153], v[36:37]
    v_pk_fma_f32 v[36:37], v[154:155], v[154:155], v[36:37]
    v_pk_fma_f32 v[36:37], v[156:157], v[156:157], v[36:37]
    v_pk_fma_f32 v[36:37], v[158:159], v[158:159], v[36:37]
    v_add_f32 v36, v36, v37
    s_nop 1
    v_add_f32_dpp v36, v36, v36 row_ror:8 row_mask:0xf bank_mask:0xf
    s_nop 1
    v_add_f32_dpp v36, v36, v36 row_ror:4 row_mask:0xf bank_mask:0xf
    s_nop 1
    v_add_f32_dpp v36, v36, v36 row_ror:2 row_mask:0xf bank_mask:0xf
    s_nop 1
    v_add_f32_dpp v36, v36, v36 row_ror:1 row_mask:0xf bank_mask:0xf
    v_mov_b32 v38, v36
    s_nop 1
    v_permlane16_swap_b32 v36, v38
    v_add_f32 v36, v36, v38
    v_mul_f32 v36, 0x3b000000, v36
    v_add_f32 v38, 0x3727c5ac, v36
    v_rsq_f32 v38, v38
    s_nop 0
    v_mul_f32 v36, v36, v38
    v_fmaak_f32 v36, v36, v38, 0x3727c5ac
    v_rsq_f32 v36, v36
    v_mul_f32 v46, 0x3fb8aa3b, v38
    v_mul_f32 v36, v36, v38
    v_pk_mul_f32 v[144:145], v[144:145], v[36:37] op_sel_hi:[1,0]
    v_pk_mul_f32 v[146:147], v[146:147], v[36:37] op_sel_hi:[1,0]
    v_pk_mul_f32 v[148:149], v[148:149], v[36:37] op_sel_hi:[1,0]
    v_pk_mul_f32 v[150:151], v[150:151], v[36:37] op_sel_hi:[1,0]
    v_cvt_pk_bf16_f32 v120, v144, v145
    v_cvt_pk_bf16_f32 v121, v146, v147
    v_cvt_pk_bf16_f32 v122, v148, v149
    v_cvt_pk_bf16_f32 v123, v150, v151
    buffer_store_dwordx4 v[120:123], v241, s[4:7], s63 offen sc1
    v_pk_mul_f32 v[152:153], v[152:153], v[36:37] op_sel_hi:[1,0]
    v_pk_mul_f32 v[154:155], v[154:155], v[36:37] op_sel_hi:[1,0]
    v_pk_mul_f32 v[156:157], v[156:157], v[36:37] op_sel_hi:[1,0]
    v_pk_mul_f32 v[158:159], v[158:159], v[36:37] op_sel_hi:[1,0]
    v_cvt_pk_bf16_f32 v124, v152, v153
    v_cvt_pk_bf16_f32 v125, v154, v155
    v_cvt_pk_bf16_f32 v126, v156, v157
    v_cvt_pk_bf16_f32 v127, v158, v159
    buffer_store_dwordx4 v[124:127], v241, s[4:7], s64 offen sc1
    s_waitcnt lgkmcnt(0)
    s_mul_i32 s32, s32, 0x41c64e6d
    s_add_u32 s32, s32, 0x6f4a7c15
    v_mov_b32 v45, v44
    v_mov_b32 v47, v46
    s_lshl_b32 s60, s62, 3
    s_add_u32 s60, s60, 393216
    v_mov_b32 v38, 0
    v_permlane32_swap_b32 v44, v45
    v_permlane32_swap_b32 v46, v47
    s_mov_b64 exec, 1
    buffer_store_dwordx4 v[44:47], v38, s[4:7], s60 offen sc1
    s_cmp_gt_u32 s3, 2
    s_cbranch_scc1 L_noinit
    s_lshl_b32 s60, s2, 8
    s_lshl_b32 s61, s3, 16
    s_add_u32 s60, s60, s61
    s_add_u32 s60, s60, 131072
    v_mov_b32 v37, s32
    buffer_store_dword v37, v38, s[4:7], s60 offen sc1
L_noinit:
    s_mov_b64 exec, -1
    s_barrier
    ds_read_b64_tr_b16 v[128:129], v10 offset:0
    ds_read_b64_tr_b16 v[130:131], v10 offset:512
    ds_read_b64_tr_b16 v[132:133], v10 offset:8192
    ds_read_b64_tr_b16 v[134:135], v10 offset:8704
    ds_read_b64_tr_b16 v[136:137], v10 offset:16384
    ds_read_b64_tr_b16 v[138:139], v10 offset:16896
    ds_read_b128 v[112:115], v4 offset:24576
    ds_read_b128 v[116:119], v4 offset:26624
    ds_read_b128 v[120:123], v4 offset:28672
    ds_read_b128 v[124:127], v4 offset:30720
    s_cmp_lg_u32 s73, 0
    s_cbranch_scc1 L_nox0
    v_add_u32 v36, 24576, v15
    v_xor_b32 v37, 16, v36
    v_xor_b32 v38, 32, v36
    v_xor_b32 v39, 48, v36
    ds_read_b64 v[20:21], v36
    ds_read_b64 v[22:23], v37
    ds_read_b64 v[24:25], v38
    ds_read_b64 v[26:27], v39
L_nox0:
    s_waitcnt lgkmcnt(0)
    v_mfma_f32_16x16x32_bf16 v[100:103], v[16:19], v[132:135], 0
    ds_read_b64_tr_b16 v[160:161], v10 offset:4096
    ds_read_b64_tr_b16 v[162:163], v10 offset:4608
    v_mfma_f32_16x16x32_bf16 v[104:107], v[16:19], v[136:139], 0
    ds_read_b64_tr_b16 v[164:165], v10 offset:12288
    ds_read_b64_tr_b16 v[166:167], v10 offset:12800
    v_mfma_f32_16x16x32_bf16 v[64:67], v[112:115], v[132:135], 0
    ds_read_b64_tr_b16 v[168:169], v10 offset:20480
    ds_read_b64_tr_b16 v[170:171], v10 offset:20992
    v_mfma_f32_16x16x32_bf16 v[80:83], v[112:115], v[136:139], 0
    ds_read_b128 v[144:147], v7 offset:24576
    ds_read_b128 v[148:151], v7 offset:26624
    v_mfma_f32_16x16x32_bf16 v[68:71], v[116:119], v[132:135], 0
    ds_read_b128 v[152:155], v7 offset:28672
    ds_read_b128 v[156:159], v7 offset:30720
    v_mfma_f32_16x16x32_bf16 v[84:87], v[116:119], v[136:139], 0
    v_mfma_f32_16x16x32_bf16 v[72:75], v[120:123], v[132:135], 0
    v_mfma_f32_16x16x32_bf16 v[88:91], v[120:123], v[136:139], 0
    v_mfma_f32_16x16x32_bf16 v[76:79], v[124:127], v[132:135], 0
    v_mfma_f32_16x16x32_bf16 v[92:95], v[124:127], v[136:139], 0
    v_mfma_f32_16x16x32_bf16 v[96:99], v[128:131], v[16:19], 0
    v_mfma_f32_16x16x32_bf16 v[48:51], v[128:131], v[112:115], 0
    v_mfma_f32_16x16x32_bf16 v[52:55], v[128:131], v[116:119], 0
    v_mfma_f32_16x16x32_bf16 v[56:59], v[128:131], v[120:123], 0
    v_mfma_f32_16x16x32_bf16 v[60:63], v[128:131], v[124:127], 0
    s_waitcnt vmcnt(0) lgkmcnt(0)
    s_barrier
    s_cmp_lg_u32 s3, 0
    s_cbranch_scc1 L_np_f0
    v_lshlrev_b32 v39, 12, v1
    v_mov_b32 v37, s32
    s_lshr_b32 s60, s2, 2
    s_lshl_b32 s60, s60, 6
    s_and_b32 s61, s2, 3
    s_lshl_b32 s61, s61, 2
    s_add_u32 s60, s60, s61
    s_add_u32 s60, s60, 4096
    s_mov_b64 exec, 255
    buffer_store_dword v37, v39, s[4:7], s60 offen sc1
    s_mov_b64 exec, -1
L_np_f0:
    v_mfma_f32_16x16x32_bf16 v[100:103], v[16:19], v[164:167], v[100:103]
    ds_read_b64_tr_b16 v[128:129], v10 offset:32768
    ds_read_b64_tr_b16 v[130:131], v10 offset:33280
    v_mfma_f32_16x16x32_bf16 v[104:107], v[16:19], v[168:171], v[104:107]
    ds_read_b64_tr_b16 v[132:133], v10 offset:40960
    ds_read_b64_tr_b16 v[134:135], v10 offset:41472
    v_mfma_f32_16x16x32_bf16 v[64:67], v[144:147], v[164:167], v[64:67]
    ds_read_b64_tr_b16 v[136:137], v10 offset:49152
    ds_read_b64_tr_b16 v[138:139], v10 offset:49664
    v_mfma_f32_16x16x32_bf16 v[80:83], v[144:147], v[168:171], v[80:83]
    ds_read_b128 v[112:115], v4 offset:57344
    ds_read_b128 v[116:119], v4 offset:59392
    v_mfma_f32_16x16x32_bf16 v[68:71], v[148:151], v[164:167], v[68:71]
    ds_read_b128 v[120:123], v4 offset:61440
    ds_read_b128 v[124:127], v4 offset:63488
    v_mfma_f32_16x16x32_bf16 v[84:87], v[148:151], v[168:171], v[84:87]
    v_mfma_f32_16x16x32_bf16 v[72:75], v[152:155], v[164:167], v[72:75]
    v_mfma_f32_16x16x32_bf16 v[88:91], v[152:155], v[168:171], v[88:91]
    v_mfma_f32_16x16x32_bf16 v[76:79], v[156:159], v[164:167], v[76:79]
    v_mfma_f32_16x16x32_bf16 v[92:95], v[156:159], v[168:171], v[92:95]
    v_mfma_f32_16x16x32_bf16 v[96:99], v[160:163], v[16:19], v[96:99]
    v_mfma_f32_16x16x32_bf16 v[48:51], v[160:163], v[144:147], v[48:51]
    v_mfma_f32_16x16x32_bf16 v[52:55], v[160:163], v[148:151], v[52:55]
    v_mfma_f32_16x16x32_bf16 v[56:59], v[160:163], v[152:155], v[56:59]
    v_mfma_f32_16x16x32_bf16 v[60:63], v[160:163], v[156:159], v[60:63]
    s_cmp_lg_u32 s73, 1
    s_cbranch_scc1 L_nox1
    v_add_u32 v36, 57344, v15
    v_xor_b32 v37, 16, v36
    v_xor_b32 v38, 32, v36
    v_xor_b32 v39, 48, v36
    ds_read_b64 v[20:21], v36
    ds_read_b64 v[22:23], v37
    ds_read_b64 v[24:25], v38
    ds_read_b64 v[26:27], v39
L_nox1:
    s_waitcnt lgkmcnt(0)
    v_mfma_f32_16x16x32_bf16 v[100:103], v[16:19], v[132:135], v[100:103]
    ds_read_b64_tr_b16 v[160:161], v10 offset:36864
    ds_read_b64_tr_b16 v[162:163], v10 offset:37376
    v_mfma_f32_16x16x32_bf16 v[104:107], v[16:19], v[136:139], v[104:107]
    ds_read_b64_tr_b16 v[164:165], v10 offset:45056
    ds_read_b64_tr_b16 v[166:167], v10 offset:45568
    v_mfma_f32_16x16x32_bf16 v[64:67], v[112:115], v[132:135], v[64:67]
    ds_read_b64_tr_b16 v[168:169], v10 offset:53248
    ds_read_b64_tr_b16 v[170:171], v10 offset:53760
    v_mfma_f32_16x16x32_bf16 v[80:83], v[112:115], v[136:139], v[80:83]
    ds_read_b128 v[144:147], v7 offset:57344
    ds_read_b128 v[148:151], v7 offset:59392
    v_mfma_f32_16x16x32_bf16 v[68:71], v[116:119], v[132:135], v[68:71]
    ds_read_b128 v[152:155], v7 offset:61440
    ds_read_b128 v[156:159], v7 offset:63488
    v_mfma_f32_16x16x32_bf16 v[84:87], v[116:119], v[136:139], v[84:87]
    v_mfma_f32_16x16x32_bf16 v[72:75], v[120:123], v[132:135], v[72:75]
    v_mfma_f32_16x16x32_bf16 v[88:91], v[120:123], v[136:139], v[88:91]
    v_mfma_f32_16x16x32_bf16 v[76:79], v[124:127], v[132:135], v[76:79]
    v_mfma_f32_16x16x32_bf16 v[92:95], v[124:127], v[136:139], v[92:95]
    v_mfma_f32_16x16x32_bf16 v[96:99], v[128:131], v[16:19], v[96:99]
    v_mfma_f32_16x16x32_bf16 v[48:51], v[128:131], v[112:115], v[48:51]
    v_mfma_f32_16x16x32_bf16 v[52:55], v[128:131], v[116:119], v[52:55]
    v_mfma_f32_16x16x32_bf16 v[56:59], v[128:131], v[120:123], v[56:59]
    v_mfma_f32_16x16x32_bf16 v[60:63], v[128:131], v[124:127], v[60:63]
    s_waitcnt lgkmcnt(0)
    s_barrier
    v_mfma_f32_16x16x32_bf16 v[100:103], v[16:19], v[164:167], v[100:103]
    ds_read_b64_tr_b16 v[128:129], v11 offset:0
    ds_read_b64_tr_b16 v[130:131], v11 offset:512
    v_mfma_f32_16x16x32_bf16 v[104:107], v[16:19], v[168:171], v[104:107]
    ds_read_b64_tr_b16 v[132:133], v11 offset:8192
    ds_read_b64_tr_b16 v[134:135], v11 offset:8704
    v_mfma_f32_16x16x32_bf16 v[64:67], v[144:147], v[164:167], v[64:67]
    ds_read_b64_tr_b16 v[136:137], v11 offset:16384
    ds_read_b64_tr_b16 v[138:139], v11 offset:16896
    v_mfma_f32_16x16x32_bf16 v[80:83], v[144:147], v[168:171], v[80:83]
    ds_read_b128 v[112:115], v5 offset:24576
    ds_read_b128 v[116:119], v5 offset:26624
    v_mfma_f32_16x16x32_bf16 v[68:71], v[148:151], v[164:167], v[68:71]
    ds_read_b128 v[120:123], v5 offset:28672
    ds_read_b128 v[124:127], v5 offset:30720
    v_mfma_f32_16x16x32_bf16 v[84:87], v[148:151], v[168:171], v[84:87]
    v_mfma_f32_16x16x32_bf16 v[72:75], v[152:155], v[164:167], v[72:75]
    v_mfma_f32_16x16x32_bf16 v[88:91], v[152:155], v[168:171], v[88:91]
    v_mfma_f32_16x16x32_bf16 v[76:79], v[156:159], v[164:167], v[76:79]
    v_mfma_f32_16x16x32_bf16 v[92:95], v[156:159], v[168:171], v[92:95]
    v_mfma_f32_16x16x32_bf16 v[96:99], v[160:163], v[16:19], v[96:99]
    v_mfma_f32_16x16x32_bf16 v[48:51], v[160:163], v[144:147], v[48:51]
    v_mfma_f32_16x16x32_bf16 v[52:55], v[160:163], v[148:151], v[52:55]
    v_mfma_f32_16x16x32_bf16 v[56:59], v[160:163], v[152:155], v[56:59]
    v_mfma_f32_16x16x32_bf16 v[60:63], v[160:163], v[156:159], v[60:63]
    s_cmp_lg_u32 s73, 2
    s_cbranch_scc1 L_nox2
    v_add_u32 v36, 90112, v15
    v_xor_b32 v37, 16, v36
    v_xor_b32 v38, 32, v36
    v_xor_b32 v39, 48, v36
    ds_read_b64 v[20:21], v36
    ds_read_b64 v[22:23], v37
    ds_read_b64 v[24:25], v38
    ds_read_b64 v[26:27], v39
L_nox2:
    s_waitcnt lgkmcnt(0)
    v_mfma_f32_16x16x32_bf16 v[100:103], v[16:19], v[132:135], v[100:103]
    ds_read_b64_tr_b16 v[160:161], v11 offset:4096
    ds_read_b64_tr_b16 v[162:163], v11 offset:4608
    v_mfma_f32_16x16x32_bf16 v[104:107], v[16:19], v[136:139], v[104:107]
    ds_read_b64_tr_b16 v[164:165], v11 offset:12288
    ds_read_b64_tr_b16 v[166:167], v11 offset:12800
    v_mfma_f32_16x16x32_bf16 v[64:67], v[112:115], v[132:135], v[64:67]
    ds_read_b64_tr_b16 v[168:169], v11 offset:20480
    ds_read_b64_tr_b16 v[170:171], v11 offset:20992
    v_mfma_f32_16x16x32_bf16 v[80:83], v[112:115], v[136:139], v[80:83]
    ds_read_b128 v[144:147], v8 offset:24576
    ds_read_b128 v[148:151], v8 offset:26624
    v_mfma_f32_16x16x32_bf16 v[68:71], v[116:119], v[132:135], v[68:71]
    ds_read_b128 v[152:155], v8 offset:28672
    ds_read_b128 v[156:159], v8 offset:30720
    v_mfma_f32_16x16x32_bf16 v[84:87], v[116:119], v[136:139], v[84:87]
    v_mfma_f32_16x16x32_bf16 v[72:75], v[120:123], v[132:135], v[72:75]
    v_mfma_f32_16x16x32_bf16 v[88:91], v[120:123], v[136:139], v[88:91]
    v_mfma_f32_16x16x32_bf16 v[76:79], v[124:127], v[132:135], v[76:79]
    v_mfma_f32_16x16x32_bf16 v[92:95], v[124:127], v[136:139], v[92:95]
    v_mfma_f32_16x16x32_bf16 v[96:99], v[128:131], v[16:19], v[96:99]
    v_mfma_f32_16x16x32_bf16 v[48:51], v[128:131], v[112:115], v[48:51]
    v_mfma_f32_16x16x32_bf16 v[52:55], v[128:131], v[116:119], v[52:55]
    v_mfma_f32_16x16x32_bf16 v[56:59], v[128:131], v[120:123], v[56:59]
    v_mfma_f32_16x16x32_bf16 v[60:63], v[128:131], v[124:127], v[60:63]
    s_waitcnt lgkmcnt(0)
    s_barrier
    v_mfma_f32_16x16x32_bf16 v[100:103], v[16:19], v[164:167], v[100:103]
    ds_read_b64_tr_b16 v[128:129], v11 offset:32768
    ds_read_b64_tr_b16 v[130:131], v11 offset:33280
    v_mfma_f32_16x16x32_bf16 v[104:107], v[16:19], v[168:171], v[104:107]
    ds_read_b64_tr_b16 v[132:133], v11 offset:40960
    ds_read_b64_tr_b16 v[134:135], v11 offset:41472
    v_mfma_f32_16x16x32_bf16 v[64:67], v[144:147], v[164:167], v[64:67]
    ds_read_b64_tr_b16 v[136:137], v11 offset:49152
    ds_read_b64_tr_b16 v[138:139], v11 offset:49664
    v_mfma_f32_16x16x32_bf16 v[80:83], v[144:147], v[168:171], v[80:83]
    ds_read_b128 v[112:115], v5 offset:57344
    ds_read_b128 v[116:119], v5 offset:59392
    v_mfma_f32_16x16x32_bf16 v[68:71], v[148:151], v[164:167], v[68:71]
    ds_read_b128 v[120:123], v5 offset:61440
    ds_read_b128 v[124:127], v5 offset:63488
    v_mfma_f32_16x16x32_bf16 v[84:87], v[148:151], v[168:171], v[84:87]
    v_mfma_f32_16x16x32_bf16 v[72:75], v[152:155], v[164:167], v[72:75]
    v_mfma_f32_16x16x32_bf16 v[88:91], v[152:155], v[168:171], v[88:91]
    v_mfma_f32_16x16x32_bf16 v[76:79], v[156:159], v[164:167], v[76:79]
    v_mfma_f32_16x16x32_bf16 v[92:95], v[156:159], v[168:171], v[92:95]
    v_mfma_f32_16x16x32_bf16 v[96:99], v[160:163], v[16:19], v[96:99]
    v_mfma_f32_16x16x32_bf16 v[48:51], v[160:163], v[144:147], v[48:51]
    v_mfma_f32_16x16x32_bf16 v[52:55], v[160:163], v[148:151], v[52:55]
    v_mfma_f32_16x16x32_bf16 v[56:59], v[160:163], v[152:155], v[56:59]
    v_mfma_f32_16x16x32_bf16 v[60:63], v[160:163], v[156:159], v[60:63]
    s_cmp_lg_u32 s73, 3
    s_cbranch_scc1 L_nox3
    v_add_u32 v36, 122880, v15
    v_xor_b32 v37, 16, v36
    v_xor_b32 v38, 32, v36
    v_xor_b32 v39, 48, v36
    ds_read_b64 v[20:21], v36
    ds_read_b64 v[22:23], v37
    ds_read_b64 v[24:25], v38
    ds_read_b64 v[26:27], v39
L_nox3:
    s_waitcnt lgkmcnt(0)
    v_mfma_f32_16x16x32_bf16 v[100:103], v[16:19], v[132:135], v[100:103]
    ds_read_b64_tr_b16 v[160:161], v11 offset:36864
    ds_read_b64_tr_b16 v[162:163], v11 offset:37376
    v_mfma_f32_16x16x32_bf16 v[104:107], v[16:19], v[136:139], v[104:107]
    ds_read_b64_tr_b16 v[164:165], v11 offset:45056
    ds_read_b64_tr_b16 v[166:167], v11 offset:45568
    v_mfma_f32_16x16x32_bf16 v[64:67], v[112:115], v[132:135], v[64:67]
    ds_read_b64_tr_b16 v[168:169], v11 offset:53248
    ds_read_b64_tr_b16 v[170:171], v11 offset:53760
    v_mfma_f32_16x16x32_bf16 v[80:83], v[112:115], v[136:139], v[80:83]
    ds_read_b128 v[144:147], v8 offset:57344
    ds_read_b128 v[148:151], v8 offset:59392
    v_mfma_f32_16x16x32_bf16 v[68:71], v[116:119], v[132:135], v[68:71]
    ds_read_b128 v[152:155], v8 offset:61440
    ds_read_b128 v[156:159], v8 offset:63488
    v_mfma_f32_16x16x32_bf16 v[84:87], v[116:119], v[136:139], v[84:87]
    v_mfma_f32_16x16x32_bf16 v[72:75], v[120:123], v[132:135], v[72:75]
    v_mfma_f32_16x16x32_bf16 v[88:91], v[120:123], v[136:139], v[88:91]
    v_mfma_f32_16x16x32_bf16 v[76:79], v[124:127], v[132:135], v[76:79]
    v_mfma_f32_16x16x32_bf16 v[92:95], v[124:127], v[136:139], v[92:95]
    v_mfma_f32_16x16x32_bf16 v[96:99], v[128:131], v[16:19], v[96:99]
    v_mfma_f32_16x16x32_bf16 v[48:51], v[128:131], v[112:115], v[48:51]
    v_mfma_f32_16x16x32_bf16 v[52:55], v[128:131], v[116:119], v[52:55]
    v_mfma_f32_16x16x32_bf16 v[56:59], v[128:131], v[120:123], v[56:59]
    v_mfma_f32_16x16x32_bf16 v[60:63], v[128:131], v[124:127], v[60:63]
    s_waitcnt lgkmcnt(0)
    s_barrier
    v_mfma_f32_16x16x32_bf16 v[100:103], v[16:19], v[164:167], v[100:103]
    ds_read_b64_tr_b16 v[128:129], v12 offset:0
    ds_read_b64_tr_b16 v[130:131], v12 offset:512
    v_mfma_f32_16x16x32_bf16 v[104:107], v[16:19], v[168:171], v[104:107]
    ds_read_b64_tr_b16 v[132:133], v12 offset:8192
    ds_read_b64_tr_b16 v[134:135], v12 offset:8704
    v_mfma_f32_16x16x32_bf16 v[64:67], v[144:147], v[164:167], v[64:67]
    ds_read_b64_tr_b16 v[136:137], v12 offset:16384
    ds_read_b64_tr_b16 v[138:139], v12 offset:16896
    v_mfma_f32_16x16x32_bf16 v[80:83], v[144:147], v[168:171], v[80:83]
    ds_read_b128 v[112:115], v4 offset:0
    ds_read_b128 v[116:119], v4 offset:2048
    v_mfma_f32_16x16x32_bf16 v[68:71], v[148:151], v[164:167], v[68:71]
    ds_read_b128 v[120:123], v4 offset:4096
    ds_read_b128 v[124:127], v4 offset:6144
    v_mfma_f32_16x16x32_bf16 v[84:87], v[148:151], v[168:171], v[84:87]
    v_mfma_f32_16x16x32_bf16 v[72:75], v[152:155], v[164:167], v[72:75]
    v_mfma_f32_16x16x32_bf16 v[88:91], v[152:155], v[168:171], v[88:91]
    v_mfma_f32_16x16x32_bf16 v[76:79], v[156:159], v[164:167], v[76:79]
    v_mfma_f32_16x16x32_bf16 v[92:95], v[156:159], v[168:171], v[92:95]
    v_mfma_f32_16x16x32_bf16 v[96:99], v[160:163], v[16:19], v[96:99]
    v_mfma_f32_16x16x32_bf16 v[48:51], v[160:163], v[144:147], v[48:51]
    v_mfma_f32_16x16x32_bf16 v[52:55], v[160:163], v[148:151], v[52:55]
    v_mfma_f32_16x16x32_bf16 v[56:59], v[160:163], v[152:155], v[56:59]
    v_mfma_f32_16x16x32_bf16 v[60:63], v[160:163], v[156:159], v[60:63]
    s_cmp_lg_u32 s73, 4
    s_cbranch_scc1 L_nox4
    v_add_u32 v36, 0, v15
    v_xor_b32 v37, 16, v36
    v_xor_b32 v38, 32, v36
    v_xor_b32 v39, 48, v36
    ds_read_b64 v[20:21], v36
    ds_read_b64 v[22:23], v37
    ds_read_b64 v[24:25], v38
    ds_read_b64 v[26:27], v39
L_nox4:
    s_waitcnt lgkmcnt(0)
    v_mfma_f32_16x16x32_bf16 v[100:103], v[16:19], v[132:135], v[100:103]
    ds_read_b64_tr_b16 v[160:161], v12 offset:4096
    ds_read_b64_tr_b16 v[162:163], v12 offset:4608
    v_mfma_f32_16x16x32_bf16 v[104:107], v[16:19], v[136:139], v[104:107]
    ds_read_b64_tr_b16 v[164:165], v12 offset:12288
    ds_read_b64_tr_b16 v[166:167], v12 offset:12800
    v_mfma_f32_16x16x32_bf16 v[64:67], v[112:115], v[132:135], v[64:67]
    ds_read_b64_tr_b16 v[168:169], v12 offset:20480
    ds_read_b64_tr_b16 v[170:171], v12 offset:20992
    v_mfma_f32_16x16x32_bf16 v[80:83], v[112:115], v[136:139], v[80:83]
    ds_read_b128 v[144:147], v7 offset:0
    ds_read_b128 v[148:151], v7 offset:2048
    v_mfma_f32_16x16x32_bf16 v[68:71], v[116:119], v[132:135], v[68:71]
    ds_read_b128 v[152:155], v7 offset:4096
    ds_read_b128 v[156:159], v7 offset:6144
    v_mfma_f32_16x16x32_bf16 v[84:87], v[116:119], v[136:139], v[84:87]
    v_mfma_f32_16x16x32_bf16 v[72:75], v[120:123], v[132:135], v[72:75]
    v_mfma_f32_16x16x32_bf16 v[88:91], v[120:123], v[136:139], v[88:91]
    v_mfma_f32_16x16x32_bf16 v[76:79], v[124:127], v[132:135], v[76:79]
    v_mfma_f32_16x16x32_bf16 v[92:95], v[124:127], v[136:139], v[92:95]
    v_mfma_f32_16x16x32_bf16 v[96:99], v[128:131], v[16:19], v[96:99]
    v_mfma_f32_16x16x32_bf16 v[48:51], v[128:131], v[112:115], v[48:51]
    v_mfma_f32_16x16x32_bf16 v[52:55], v[128:131], v[116:119], v[52:55]
    v_mfma_f32_16x16x32_bf16 v[56:59], v[128:131], v[120:123], v[56:59]
    v_mfma_f32_16x16x32_bf16 v[60:63], v[128:131], v[124:127], v[60:63]
    s_waitcnt lgkmcnt(0)
    s_barrier
    v_mfma_f32_16x16x32_bf16 v[100:103], v[16:19], v[164:167], v[100:103]
    ds_read_b64_tr_b16 v[128:129], v10 offset:8192
    ds_read_b64_tr_b16 v[130:131], v10 offset:8704
    v_mfma_f32_16x16x32_bf16 v[104:107], v[16:19], v[168:171], v[104:107]
    ds_read_b64_tr_b16 v[132:133], v10 offset:16384
    ds_read_b64_tr_b16 v[134:135], v10 offset:16896
    v_mfma_f32_16x16x32_bf16 v[64:67], v[144:147], v[164:167], v[64:67]
    ds_read_b64_tr_b16 v[136:137], v10 offset:24576
    ds_read_b64_tr_b16 v[138:139], v10 offset:25088
    v_mfma_f32_16x16x32_bf16 v[80:83], v[144:147], v[168:171], v[80:83]
    ds_read_b128 v[112:115], v4 offset:32768
    ds_read_b128 v[116:119], v4 offset:34816
    v_mfma_f32_16x16x32_bf16 v[68:71], v[148:151], v[164:167], v[68:71]
    ds_read_b128 v[120:123], v4 offset:36864
    ds_read_b128 v[124:127], v4 offset:38912
    v_mfma_f32_16x16x32_bf16 v[84:87], v[148:151], v[168:171], v[84:87]
    v_mfma_f32_16x16x32_bf16 v[72:75], v[152:155], v[164:167], v[72:75]
    v_mfma_f32_16x16x32_bf16 v[88:91], v[152:155], v[168:171], v[88:91]
    v_mfma_f32_16x16x32_bf16 v[76:79], v[156:159], v[164:167], v[76:79]
    v_mfma_f32_16x16x32_bf16 v[92:95], v[156:159], v[168:171], v[92:95]
    v_mfma_f32_16x16x32_bf16 v[96:99], v[160:163], v[16:19], v[96:99]
    v_mfma_f32_16x16x32_bf16 v[48:51], v[160:163], v[144:147], v[48:51]
    v_mfma_f32_16x16x32_bf16 v[52:55], v[160:163], v[148:151], v[52:55]
    v_mfma_f32_16x16x32_bf16 v[56:59], v[160:163], v[152:155], v[56:59]
    v_mfma_f32_16x16x32_bf16 v[60:63], v[160:163], v[156:159], v[60:63]
    s_cmp_lg_u32 s73, 5
    s_cbranch_scc1 L_nox5
    v_add_u32 v36, 32768, v15
    v_xor_b32 v37, 16, v36
    v_xor_b32 v38, 32, v36
    v_xor_b32 v39, 48, v36
    ds_read_b64 v[20:21], v36
    ds_read_b64 v[22:23], v37
    ds_read_b64 v[24:25], v38
    ds_read_b64 v[26:27], v39
L_nox5:
    s_waitcnt lgkmcnt(0)
    v_mfma_f32_16x16x32_bf16 v[100:103], v[16:19], v[132:135], v[100:103]
    ds_read_b64_tr_b16 v[160:161], v10 offset:12288
    ds_read_b64_tr_b16 v[162:163], v10 offset:12800
    v_mfma_f32_16x16x32_bf16 v[104:107], v[16:19], v[136:139], v[104:107]
    ds_read_b64_tr_b16 v[164:165], v10 offset:20480
    ds_read_b64_tr_b16 v[166:167], v10 offset:20992
    v_mfma_f32_16x16x32_bf16 v[64:67], v[112:115], v[132:135], v[64:67]
    ds_read_b64_tr_b16 v[168:169], v10 offset:28672
    ds_read_b64_tr_b16 v[170:171], v10 offset:29184
    v_mfma_f32_16x16x32_bf16 v[80:83], v[112:115], v[136:139], v[80:83]
    ds_read_b128 v[144:147], v7 offset:32768
    ds_read_b128 v[148:151], v7 offset:34816
    v_mfma_f32_16x16x32_bf16 v[68:71], v[116:119], v[132:135], v[68:71]
    ds_read_b128 v[152:155], v7 offset:36864
    ds_read_b128 v[156:159], v7 offset:38912
    v_mfma_f32_16x16x32_bf16 v[84:87], v[116:119], v[136:139], v[84:87]
    v_mfma_f32_16x16x32_bf16 v[72:75], v[120:123], v[132:135], v[72:75]
    v_mfma_f32_16x16x32_bf16 v[88:91], v[120:123], v[136:139], v[88:91]
    v_mfma_f32_16x16x32_bf16 v[76:79], v[124:127], v[132:135], v[76:79]
    v_mfma_f32_16x16x32_bf16 v[92:95], v[124:127], v[136:139], v[92:95]
    v_mfma_f32_16x16x32_bf16 v[96:99], v[128:131], v[16:19], v[96:99]
    v_mfma_f32_16x16x32_bf16 v[48:51], v[128:131], v[112:115], v[48:51]
    v_mfma_f32_16x16x32_bf16 v[52:55], v[128:131], v[116:119], v[52:55]
    v_mfma_f32_16x16x32_bf16 v[56:59], v[128:131], v[120:123], v[56:59]
    v_mfma_f32_16x16x32_bf16 v[60:63], v[128:131], v[124:127], v[60:63]
    s_waitcnt lgkmcnt(0)
    s_barrier
    v_mfma_f32_16x16x32_bf16 v[100:103], v[16:19], v[164:167], v[100:103]
    ds_read_b64_tr_b16 v[128:129], v10 offset:40960
    ds_read_b64_tr_b16 v[130:131], v10 offset:41472
    v_mfma_f32_16x16x32_bf16 v[104:107], v[16:19], v[168:171], v[104:107]
    ds_read_b64_tr_b16 v[132:133], v10 offset:49152
    ds_read_b64_tr_b16 v[134:135], v10 offset:49664
    v_mfma_f32_16x16x32_bf16 v[64:67], v[144:147], v[164:167], v[64:67]
    ds_read_b64_tr_b16 v[136:137], v10 offset:57344
    ds_read_b64_tr_b16 v[138:139], v10 offset:57856
    v_mfma_f32_16x16x32_bf16 v[80:83], v[144:147], v[168:171], v[80:83]
    ds_read_b128 v[112:115], v5 offset:0
    ds_read_b128 v[116:119], v5 offset:2048
    v_mfma_f32_16x16x32_bf16 v[68:71], v[148:151], v[164:167], v[68:71]
    ds_read_b128 v[120:123], v5 offset:4096
    ds_read_b128 v[124:127], v5 offset:6144
    v_mfma_f32_16x16x32_bf16 v[84:87], v[148:151], v[168:171], v[84:87]
    v_mfma_f32_16x16x32_bf16 v[72:75], v[152:155], v[164:167], v[72:75]
    v_mfma_f32_16x16x32_bf16 v[88:91], v[152:155], v[168:171], v[88:91]
    v_mfma_f32_16x16x32_bf16 v[76:79], v[156:159], v[164:167], v[76:79]
    v_mfma_f32_16x16x32_bf16 v[92:95], v[156:159], v[168:171], v[92:95]
    v_mfma_f32_16x16x32_bf16 v[96:99], v[160:163], v[16:19], v[96:99]
    v_mfma_f32_16x16x32_bf16 v[48:51], v[160:163], v[144:147], v[48:51]
    v_mfma_f32_16x16x32_bf16 v[52:55], v[160:163], v[148:151], v[52:55]
    v_mfma_f32_16x16x32_bf16 v[56:59], v[160:163], v[152:155], v[56:59]
    v_mfma_f32_16x16x32_bf16 v[60:63], v[160:163], v[156:159], v[60:63]
    s_cmp_lg_u32 s73, 6
    s_cbranch_scc1 L_nox6
    v_add_u32 v36, 65536, v15
    v_xor_b32 v37, 16, v36
    v_xor_b32 v38, 32, v36
    v_xor_b32 v39, 48, v36
    ds_read_b64 v[20:21], v36
    ds_read_b64 v[22:23], v37
    ds_read_b64 v[24:25], v38
    ds_read_b64 v[26:27], v39
L_nox6:
    s_waitcnt lgkmcnt(0)
    v_mfma_f32_16x16x32_bf16 v[100:103], v[16:19], v[132:135], v[100:103]
    ds_read_b64_tr_b16 v[160:161], v10 offset:45056
    ds_read_b64_tr_b16 v[162:163], v10 offset:45568
    v_mfma_f32_16x16x32_bf16 v[104:107], v[16:19], v[136:139], v[104:107]
    ds_read_b64_tr_b16 v[164:165], v10 offset:53248
    ds_read_b64_tr_b16 v[166:167], v10 offset:53760
    v_mfma_f32_16x16x32_bf16 v[64:67], v[112:115], v[132:135], v[64:67]
    ds_read_b64_tr_b16 v[168:169], v10 offset:61440
    ds_read_b64_tr_b16 v[170:171], v10 offset:61952
    v_mfma_f32_16x16x32_bf16 v[80:83], v[112:115], v[136:139], v[80:83]
    ds_read_b128 v[144:147], v8 offset:0
    ds_read_b128 v[148:151], v8 offset:2048
    v_mfma_f32_16x16x32_bf16 v[68:71], v[116:119], v[132:135], v[68:71]
    ds_read_b128 v[152:155], v8 offset:4096
    ds_read_b128 v[156:159], v8 offset:6144
    v_mfma_f32_16x16x32_bf16 v[84:87], v[116:119], v[136:139], v[84:87]
    v_mfma_f32_16x16x32_bf16 v[72:75], v[120:123], v[132:135], v[72:75]
    v_mfma_f32_16x16x32_bf16 v[88:91], v[120:123], v[136:139], v[88:91]
    v_mfma_f32_16x16x32_bf16 v[76:79], v[124:127], v[132:135], v[76:79]
    v_mfma_f32_16x16x32_bf16 v[92:95], v[124:127], v[136:139], v[92:95]
    v_mfma_f32_16x16x32_bf16 v[96:99], v[128:131], v[16:19], v[96:99]
    v_mfma_f32_16x16x32_bf16 v[48:51], v[128:131], v[112:115], v[48:51]
    v_mfma_f32_16x16x32_bf16 v[52:55], v[128:131], v[116:119], v[52:55]
    v_mfma_f32_16x16x32_bf16 v[56:59], v[128:131], v[120:123], v[56:59]
    v_mfma_f32_16x16x32_bf16 v[60:63], v[128:131], v[124:127], v[60:63]
    s_waitcnt lgkmcnt(0)
    s_barrier
    v_mfma_f32_16x16x32_bf16 v[100:103], v[16:19], v[164:167], v[100:103]
    ds_read_b64_tr_b16 v[128:129], v11 offset:8192
    ds_read_b64_tr_b16 v[130:131], v11 offset:8704
    v_mfma_f32_16x16x32_bf16 v[104:107], v[16:19], v[168:171], v[104:107]
    ds_read_b64_tr_b16 v[132:133], v11 offset:16384
    ds_read_b64_tr_b16 v[134:135], v11 offset:16896
    v_mfma_f32_16x16x32_bf16 v[64:67], v[144:147], v[164:167], v[64:67]
    ds_read_b64_tr_b16 v[136:137], v11 offset:24576
    ds_read_b64_tr_b16 v[138:139], v11 offset:25088
    v_mfma_f32_16x16x32_bf16 v[80:83], v[144:147], v[168:171], v[80:83]
    ds_read_b128 v[112:115], v5 offset:32768
    ds_read_b128 v[116:119], v5 offset:34816
    v_mfma_f32_16x16x32_bf16 v[68:71], v[148:151], v[164:167], v[68:71]
    ds_read_b128 v[120:123], v5 offset:36864
    ds_read_b128 v[124:127], v5 offset:38912
    v_mfma_f32_16x16x32_bf16 v[84:87], v[148:151], v[168:171], v[84:87]
    v_mfma_f32_16x16x32_bf16 v[72:75], v[152:155], v[164:167], v[72:75]
    v_mfma_f32_16x16x32_bf16 v[88:91], v[152:155], v[168:171], v[88:91]
    v_mfma_f32_16x16x32_bf16 v[76:79], v[156:159], v[164:167], v[76:79]
    v_mfma_f32_16x16x32_bf16 v[92:95], v[156:159], v[168:171], v[92:95]
    v_mfma_f32_16x16x32_bf16 v[96:99], v[160:163], v[16:19], v[96:99]
    v_mfma_f32_16x16x32_bf16 v[48:51], v[160:163], v[144:147], v[48:51]
    v_mfma_f32_16x16x32_bf16 v[52:55], v[160:163], v[148:151], v[52:55]
    v_mfma_f32_16x16x32_bf16 v[56:59], v[160:163], v[152:155], v[56:59]
    v_mfma_f32_16x16x32_bf16 v[60:63], v[160:163], v[156:159], v[60:63]
    s_cmp_lg_u32 s73, 7
    s_cbranch_scc1 L_nox7
    v_add_u32 v36, 98304, v15
    v_xor_b32 v37, 16, v36
    v_xor_b32 v38, 32, v36
    v_xor_b32 v39, 48, v36
    ds_read_b64 v[20:21], v36
    ds_read_b64 v[22:23], v37
    ds_read_b64 v[24:25], v38
    ds_read_b64 v[26:27], v39
L_nox7:
    s_lshl_b32 s60, s71, 6
    s_add_u32 s60, s60, 156672
    v_lshl_add_u32 v36, v43, 3, s60
    s_lshl_b32 s60, s72, 6
    s_add_u32 s60, s60, 156928
    v_lshl_add_u32 v37, v42, 1, s60
    s_waitcnt lgkmcnt(0)
    v_mfma_f32_16x16x32_bf16 v[100:103], v[16:19], v[132:135], v[100:103]
    ds_read_b64_tr_b16 v[160:161], v11 offset:12288
    ds_read_b64_tr_b16 v[162:163], v11 offset:12800
    v_mfma_f32_16x16x32_bf16 v[104:107], v[16:19], v[136:139], v[104:107]
    ds_read_b64_tr_b16 v[164:165], v11 offset:20480
    ds_read_b64_tr_b16 v[166:167], v11 offset:20992
    v_mfma_f32_16x16x32_bf16 v[64:67], v[112:115], v[132:135], v[64:67]
    ds_read_b64_tr_b16 v[168:169], v11 offset:28672
    ds_read_b64_tr_b16 v[170:171], v11 offset:29184
    v_mfma_f32_16x16x32_bf16 v[80:83], v[112:115], v[136:139], v[80:83]
    ds_read_b128 v[144:147], v8 offset:32768
    ds_read_b128 v[148:151], v8 offset:34816
    v_mfma_f32_16x16x32_bf16 v[68:71], v[116:119], v[132:135], v[68:71]
    ds_read_b128 v[152:155], v8 offset:36864
    ds_read_b128 v[156:159], v8 offset:38912
    v_mfma_f32_16x16x32_bf16 v[84:87], v[116:119], v[136:139], v[84:87]
    ds_read_b64 v[232:233], v36 offset:0
    ds_read_b64 v[234:235], v36 offset:16
    v_mfma_f32_16x16x32_bf16 v[72:75], v[120:123], v[132:135], v[72:75]
    ds_read_b64 v[236:237], v36 offset:32
    ds_read_b64 v[238:239], v36 offset:48
    v_mfma_f32_16x16x32_bf16 v[88:91], v[120:123], v[136:139], v[88:91]
    ds_read_u16 v249, v37
    v_mfma_f32_16x16x32_bf16 v[76:79], v[124:127], v[132:135], v[76:79]
    v_mfma_f32_16x16x32_bf16 v[92:95], v[124:127], v[136:139], v[92:95]
    v_mfma_f32_16x16x32_bf16 v[96:99], v[128:131], v[16:19], v[96:99]
    v_mfma_f32_16x16x32_bf16 v[48:51], v[128:131], v[112:115], v[48:51]
    v_mfma_f32_16x16x32_bf16 v[52:55], v[128:131], v[116:119], v[52:55]
    v_mfma_f32_16x16x32_bf16 v[56:59], v[128:131], v[120:123], v[56:59]
    v_mfma_f32_16x16x32_bf16 v[60:63], v[128:131], v[124:127], v[60:63]
    s_waitcnt lgkmcnt(0)
    v_lshrrev_b32 v36, 1, v2
    v_lshlrev_b32 v36, 4, v36
    v_and_b32 v37, 1, v2
    v_lshl_add_u32 v36, v37, 2, v36
    v_add_u32 v36, 155648, v36
    v_lshlrev_b32 v37, 5, v3
    v_add_u32 v37, 155648, v37
    s_barrier
    v_mfma_f32_16x16x32_bf16 v[100:103], v[16:19], v[164:167], v[100:103]
    ds_read_b128 v[184:187], v37 offset:0
    ds_read_b128 v[188:191], v37 offset:16
    v_mfma_f32_16x16x32_bf16 v[104:107], v[16:19], v[168:171], v[104:107]
    ds_read_b128 v[192:195], v37 offset:128
    ds_read_b128 v[196:199], v37 offset:144
    v_mfma_f32_16x16x32_bf16 v[64:67], v[144:147], v[164:167], v[64:67]
    ds_read_b128 v[200:203], v37 offset:256
    ds_read_b128 v[204:207], v37 offset:272
    v_mfma_f32_16x16x32_bf16 v[80:83], v[144:147], v[168:171], v[80:83]
    ds_read_b128 v[208:211], v37 offset:384
    ds_read_b128 v[212:215], v37 offset:400
    v_mfma_f32_16x16x32_bf16 v[68:71], v[148:151], v[164:167], v[68:71]
    ds_read2_b32 v[176:177], v36 offset0:0 offset1:2
    ds_read2_b32 v[178:179], v36 offset0:32 offset1:34
    v_mfma_f32_16x16x32_bf16 v[84:87], v[148:151], v[168:171], v[84:87]
    ds_read2_b32 v[180:181], v36 offset0:64 offset1:66
    ds_read2_b32 v[182:183], v36 offset0:96 offset1:98
    v_mfma_f32_16x16x32_bf16 v[72:75], v[152:155], v[164:167], v[72:75]
    v_lshl_add_u32 v39, v43, 2, v13
    v_lshlrev_b32 v39, 7, v39
    v_mfma_f32_16x16x32_bf16 v[88:91], v[152:155], v[168:171], v[88:91]
    v_and_b32 v41, 1, v3
    v_lshl_add_u32 v39, v41, 5, v39
    v_mfma_f32_16x16x32_bf16 v[76:79], v[156:159], v[164:167], v[76:79]
    v_add_u32 v39, v39, v14
    v_lshrrev_b32 v41, 1, v13
    v_mfma_f32_16x16x32_bf16 v[92:95], v[156:159], v[168:171], v[92:95]
    v_xor_b32 v4, s71, v41
    v_lshl_add_u32 v4, v4, 6, v39
    v_mfma_f32_16x16x32_bf16 v[96:99], v[160:163], v[16:19], v[96:99]
    v_xor_b32 v10, s72, v41
    v_lshl_add_u32 v10, v10, 6, v39
    v_mfma_f32_16x16x32_bf16 v[48:51], v[160:163], v[144:147], v[48:51]
    v_add_u32 v5, 0x10000, v4
    v_add_u32 v6, 0x20000, v4
    v_mfma_f32_16x16x32_bf16 v[52:55], v[160:163], v[148:151], v[52:55]
    v_add_u32 v11, 0x10000, v10
    v_add_u32 v12, 0x20000, v10
    v_mfma_f32_16x16x32_bf16 v[56:59], v[160:163], v[152:155], v[56:59]
    v_lshlrev_b32 v46, 4, v1
    v_lshrrev_b32 v44, 3, v1
    v_mfma_f32_16x16x32_bf16 v[60:63], v[160:163], v[156:159], v[60:63]
    v_and_b32 v45, 0x70, v46
    v_lshl_add_u32 v44, v44, 12, v45
    v_and_b32 v45, 3, v2
    s_waitcnt lgkmcnt(0)
    s_mov_b32 s60, 0x35c1a2a0
    s_mov_b32 s61, 0x3f317218
    v_pk_fma_f32 v[64:65], v[184:185], v[100:101], v[64:65] neg_lo:[1,0,0] neg_hi:[1,0,0]
    v_pk_fma_f32 v[66:67], v[188:189], v[100:101], v[66:67] neg_lo:[1,0,0] neg_hi:[1,0,0]
    v_pk_fma_f32 v[64:65], v[64:65], v[186:187], s[60:61] op_sel_hi:[1,1,0]
    v_pk_fma_f32 v[66:67], v[66:67], v[190:191], s[60:61] op_sel_hi:[1,1,0]
    v_exp_f32_e64 v128, v64 clamp
    v_exp_f32_e64 v129, v65 clamp
    v_exp_f32_e64 v130, v66 clamp
    v_exp_f32_e64 v131, v67 clamp
    v_max_f32 v64, s60, v64
    v_max_f32 v65, s60, v65
    v_max_f32 v66, s60, v66
    v_max_f32 v67, s60, v67
    v_pk_fma_f32 v[64:65], v[64:65], s[60:61], v[128:129] op_sel:[0,1,0] op_sel_hi:[1,1,1]
    v_pk_fma_f32 v[66:67], v[66:67], s[60:61], v[130:131] op_sel:[0,1,0] op_sel_hi:[1,1,1]
    v_cvt_pk_bf16_f32 v112, v64, v65
    v_cvt_pk_bf16_f32 v113, v66, v67
    v_pk_fma_f32 v[80:81], v[184:185], v[104:105], v[80:81] neg_lo:[1,0,0] neg_hi:[1,0,0]
    v_pk_fma_f32 v[82:83], v[188:189], v[104:105], v[82:83] neg_lo:[1,0,0] neg_hi:[1,0,0]
    v_pk_mul_f32 v[80:81], v[80:81], v[186:187]
    v_pk_mul_f32 v[82:83], v[82:83], v[190:191]
    v_cvt_pk_bf16_f32 v120, v80, v81
    v_cvt_pk_bf16_f32 v121, v82, v83
    v_pk_fma_f32 v[68:69], v[192:193], v[100:101], v[68:69] neg_lo:[1,0,0] neg_hi:[1,0,0]
    v_pk_fma_f32 v[70:71], v[196:197], v[100:101], v[70:71] neg_lo:[1,0,0] neg_hi:[1,0,0]
    v_pk_fma_f32 v[68:69], v[68:69], v[194:195], s[60:61] op_sel_hi:[1,1,0]
    v_pk_fma_f32 v[70:71], v[70:71], v[198:199], s[60:61] op_sel_hi:[1,1,0]
    v_exp_f32_e64 v128, v68 clamp
    v_exp_f32_e64 v129, v69 clamp
    v_exp_f32_e64 v130, v70 clamp
    v_exp_f32_e64 v131, v71 clamp
    v_max_f32 v68, s60, v68
    v_max_f32 v69, s60, v69
    v_max_f32 v70, s60, v70
    v_max_f32 v71, s60, v71
    v_pk_fma_f32 v[68:69], v[68:69], s[60:61], v[128:129] op_sel:[0,1,0] op_sel_hi:[1,1,1]
    v_pk_fma_f32 v[70:71], v[70:71], s[60:61], v[130:131] op_sel:[0,1,0] op_sel_hi:[1,1,1]
    v_cvt_pk_bf16_f32 v114, v68, v69
    v_cvt_pk_bf16_f32 v115, v70, v71
    v_pk_fma_f32 v[84:85], v[192:193], v[104:105], v[84:85] neg_lo:[1,0,0] neg_hi:[1,0,0]
    v_pk_fma_f32 v[86:87], v[196:197], v[104:105], v[86:87] neg_lo:[1,0,0] neg_hi:[1,0,0]
    v_pk_mul_f32 v[84:85], v[84:85], v[194:195]
    v_pk_mul_f32 v[86:87], v[86:87], v[198:199]
    v_cvt_pk_bf16_f32 v122, v84, v85
    v_cvt_pk_bf16_f32 v123, v86, v87
    v_pk_fma_f32 v[72:73], v[200:201], v[100:101], v[72:73] neg_lo:[1,0,0] neg_hi:[1,0,0]
    v_pk_fma_f32 v[74:75], v[204:205], v[100:101], v[74:75] neg_lo:[1,0,0] neg_hi:[1,0,0]
    v_pk_fma_f32 v[72:73], v[72:73], v[202:203], s[60:61] op_sel_hi:[1,1,0]
    v_pk_fma_f32 v[74:75], v[74:75], v[206:207], s[60:61] op_sel_hi:[1,1,0]
    v_exp_f32_e64 v128, v72 clamp
    v_exp_f32_e64 v129, v73 clamp
    v_exp_f32_e64 v130, v74 clamp
    v_exp_f32_e64 v131, v75 clamp
    v_max_f32 v72, s60, v72
    v_max_f32 v73, s60, v73
    v_max_f32 v74, s60, v74
    v_max_f32 v75, s60, v75
    v_pk_fma_f32 v[72:73], v[72:73], s[60:61], v[128:129] op_sel:[0,1,0] op_sel_hi:[1,1,1]
    v_pk_fma_f32 v[74:75], v[74:75], s[60:61], v[130:131] op_sel:[0,1,0] op_sel_hi:[1,1,1]
    v_cvt_pk_bf16_f32 v116, v72, v73
    v_cvt_pk_bf16_f32 v117, v74, v75
    v_pk_fma_f32 v[88:89], v[200:201], v[104:105], v[88:89] neg_lo:[1,0,0] neg_hi:[1,0,0]
    v_pk_fma_f32 v[90:91], v[204:205], v[104:105], v[90:91] neg_lo:[1,0,0] neg_hi:[1,0,0]
    v_pk_mul_f32 v[88:89], v[88:89], v[202:203]
    v_pk_mul_f32 v[90:91], v[90:91], v[206:207]
    v_cvt_pk_bf16_f32 v124, v88, v89
    v_cvt_pk_bf16_f32 v125, v90, v91
    v_pk_fma_f32 v[76:77], v[208:209], v[100:101], v[76:77] neg_lo:[1,0,0] neg_hi:[1,0,0]
    v_pk_fma_f32 v[78:79], v[212:213], v[100:101], v[78:79] neg_lo:[1,0,0] neg_hi:[1,0,0]
    v_pk_fma_f32 v[76:77], v[76:77], v[210:211], s[60:61] op_sel_hi:[1,1,0]
    v_pk_fma_f32 v[78:79], v[78:79], v[214:215], s[60:61] op_sel_hi:[1,1,0]
    v_exp_f32_e64 v128, v76 clamp
    v_exp_f32_e64 v129, v77 clamp
    v_exp_f32_e64 v130, v78 clamp
    v_exp_f32_e64 v131, v79 clamp
    v_max_f32 v76, s60, v76
    v_max_f32 v77, s60, v77
    v_max_f32 v78, s60, v78
    v_max_f32 v79, s60, v79
    v_pk_fma_f32 v[76:77], v[76:77], s[60:61], v[128:129] op_sel:[0,1,0] op_sel_hi:[1,1,1]
    v_pk_fma_f32 v[78:79], v[78:79], s[60:61], v[130:131] op_sel:[0,1,0] op_sel_hi:[1,1,1]
    v_cvt_pk_bf16_f32 v118, v76, v77
    v_cvt_pk_bf16_f32 v119, v78, v79
    v_pk_fma_f32 v[92:93], v[208:209], v[104:105], v[92:93] neg_lo:[1,0,0] neg_hi:[1,0,0]
    v_pk_fma_f32 v[94:95], v[212:213], v[104:105], v[94:95] neg_lo:[1,0,0] neg_hi:[1,0,0]
    v_pk_mul_f32 v[92:93], v[92:93], v[210:211]
    v_pk_mul_f32 v[94:95], v[94:95], v[214:215]
    v_cvt_pk_bf16_f32 v126, v92, v93
    v_cvt_pk_bf16_f32 v127, v94, v95
    v_mfma_f32_16x16x32_bf16 v[132:135], v[112:115], v[120:123], 0
    v_mfma_f32_16x16x32_bf16 v[136:139], v[112:115], v[16:19], 0
    v_mfma_f32_16x16x32_bf16 v[132:135], v[116:119], v[124:127], v[132:135]
    v_mfma_f32_16x16x32_bf16 v[136:139], v[116:119], v[16:19], v[136:139]
    s_lshl_b32 s70, s35, 2
    s_add_u32 s70, s70, s3
    s_lshl_b32 s69, s70, 8
    s_add_u32 s69, s69, 180224
    s_lshl_b32 s62, s70, 15
    s_lshl_b32 s63, s34, 7
    s_add_u32 s62, s62, s63
    s_add_u32 s62, s62, 1048576
    s_lshl_b32 s70, s70, 10
    s_add_u32 s70, s70, 524288
    v_lshlrev_b32 v64, 16, v232
    v_and_b32 v65, 0xffff0000, v232
    v_lshlrev_b32 v66, 16, v233
    v_and_b32 v67, 0xffff0000, v233
    v_lshlrev_b32 v68, 16, v234
    v_and_b32 v69, 0xffff0000, v234
    v_lshlrev_b32 v70, 16, v235
    v_and_b32 v71, 0xffff0000, v235
    v_lshlrev_b32 v72, 16, v236
    v_and_b32 v73, 0xffff0000, v236
    v_lshlrev_b32 v74, 16, v237
    v_and_b32 v75, 0xffff0000, v237
    v_lshlrev_b32 v76, 16, v238
    v_and_b32 v77, 0xffff0000, v238
    v_lshlrev_b32 v78, 16, v239
    v_and_b32 v79, 0xffff0000, v239
    v_pk_mul_f32 v[132:133], v[132:133], s[60:61] op_sel:[0,1] op_sel_hi:[1,1]
    v_pk_mul_f32 v[134:135], v[134:135], s[60:61] op_sel:[0,1] op_sel_hi:[1,1]
    v_cmp_eq_u32 vcc, 1, v45
    v_cvt_pk_bf16_f32 v132, v132, v133
    v_cvt_pk_bf16_f32 v133, v134, v135
    v_cndmask_b32 v134, v136, v137, vcc
    v_cmp_eq_u32 vcc, 2, v45
    v_mov_b32 v135, s32
    v_mov_b32 v36, 0
    v_cndmask_b32 v134, v134, v138, vcc
    v_cmp_eq_u32 vcc, 3, v45
    v_mov_b32 v37, 1
    s_nop 0
    v_cndmask_b32 v134, v134, v139, vcc
    buffer_store_dwordx4 v[132:135], v44, s[4:7], s62 offen sc1
    s_mov_b64 exec, 1
    buffer_atomic_add v37, v36, s[4:7], s69 offen
    s_mov_b64 exec, -1
    s_add_u32 s60, s2, s3
    s_cmp_lg_u32 s60, 0
    s_cbranch_scc1 L_noepoch
    v_mov_b32 v36, s32
    v_mov_b32 v37, 0
    s_mov_b64 exec, 1
    buffer_store_dword v36, v37, s[4:7], 0 offen sc1
    s_mov_b64 exec, -1
L_noepoch:
    s_cmp_eq_u32 s54, 0
    s_cbranch_scc1 L_chelper
    s_barrier
    ds_read_b64_tr_b16 v[112:113], v5 offset:40960
    ds_read_b64_tr_b16 v[114:115], v5 offset:41984
    ds_read_b64_tr_b16 v[116:117], v11 offset:57344
    ds_read_b64_tr_b16 v[118:119], v11 offset:58368
    ds_read_b64_tr_b16 v[120:121], v5 offset:49152
    ds_read_b64_tr_b16 v[122:123], v5 offset:50176
    ds_read_b64_tr_b16 v[124:125], v12 offset:0
    ds_read_b64_tr_b16 v[126:127], v12 offset:1024
    ds_read_b64_tr_b16 v[128:129], v5 offset:43008
    ds_read_b64_tr_b16 v[130:131], v5 offset:44032
    ds_read_b64_tr_b16 v[132:133], v11 offset:59392
    ds_read_b64_tr_b16 v[134:135], v11 offset:60416
    ds_read_b64_tr_b16 v[136:137], v5 offset:51200
    ds_read_b64_tr_b16 v[138:139], v5 offset:52224
    ds_read_b64_tr_b16 v[140:141], v12 offset:2048
    ds_read_b64_tr_b16 v[142:143], v12 offset:3072
    s_waitcnt lgkmcnt(0)
    v_mfma_f32_32x32x16_bf16 v[64:79], v[112:115], v[116:119], v[64:79]
    ds_read_b64_tr_b16 v[144:145], v5 offset:45056
    ds_read_b64_tr_b16 v[146:147], v5 offset:46080
    ds_read_b64_tr_b16 v[148:149], v11 offset:61440
    ds_read_b64_tr_b16 v[150:151], v11 offset:62464
    v_mfma_f32_32x32x16_bf16 v[80:95], v[120:123], v[116:119], 0
    ds_read_b64_tr_b16 v[152:153], v5 offset:53248
    ds_read_b64_tr_b16 v[154:155], v5 offset:54272
    ds_read_b64_tr_b16 v[156:157], v12 offset:4096
    ds_read_b64_tr_b16 v[158:159], v12 offset:5120
    v_mfma_f32_32x32x16_bf16 v[184:199], v[112:115], v[124:127], 0
    ds_read_b64_tr_b16 v[160:161], v5 offset:47104
    ds_read_b64_tr_b16 v[162:163], v5 offset:48128
    ds_read_b64_tr_b16 v[164:165], v11 offset:63488
    ds_read_b64_tr_b16 v[166:167], v11 offset:64512
    v_mfma_f32_32x32x16_bf16 v[200:215], v[120:123], v[124:127], 0
    ds_read_b64_tr_b16 v[168:169], v5 offset:55296
    ds_read_b64_tr_b16 v[170:171], v5 offset:56320
    ds_read_b64_tr_b16 v[172:173], v12 offset:6144
    ds_read_b64_tr_b16 v[174:175], v12 offset:7168
    v_mfma_f32_32x32x16_bf16 v[64:79], v[128:131], v[132:135], v[64:79]
    v_mfma_f32_32x32x16_bf16 v[80:95], v[136:139], v[132:135], v[80:95]
    v_mfma_f32_32x32x16_bf16 v[184:199], v[128:131], v[140:143], v[184:199]
    v_mfma_f32_32x32x16_bf16 v[200:215], v[136:139], v[140:143], v[200:215]
    s_waitcnt lgkmcnt(0)
    s_barrier
    v_mfma_f32_32x32x16_bf16 v[64:79], v[144:147], v[148:151], v[64:79]
    ds_read_b64_tr_b16 v[112:113], v6 offset:8192
    ds_read_b64_tr_b16 v[114:115], v6 offset:9216
    ds_read_b64_tr_b16 v[116:117], v10 offset:0
    ds_read_b64_tr_b16 v[118:119], v10 offset:1024
    v_mfma_f32_32x32x16_bf16 v[80:95], v[152:155], v[148:151], v[80:95]
    ds_read_b64_tr_b16 v[120:121], v6 offset:16384
    ds_read_b64_tr_b16 v[122:123], v6 offset:17408
    ds_read_b64_tr_b16 v[124:125], v10 offset:8192
    ds_read_b64_tr_b16 v[126:127], v10 offset:9216
    v_mfma_f32_32x32x16_bf16 v[184:199], v[144:147], v[156:159], v[184:199]
    ds_read_b64_tr_b16 v[128:129], v6 offset:10240
    ds_read_b64_tr_b16 v[130:131], v6 offset:11264
    ds_read_b64_tr_b16 v[132:133], v10 offset:2048
    ds_read_b64_tr_b16 v[134:135], v10 offset:3072
    v_mfma_f32_32x32x16_bf16 v[200:215], v[152:155], v[156:159], v[200:215]
    ds_read_b64_tr_b16 v[136:137], v6 offset:18432
    ds_read_b64_tr_b16 v[138:139], v6 offset:19456
    ds_read_b64_tr_b16 v[140:141], v10 offset:10240
    ds_read_b64_tr_b16 v[142:143], v10 offset:11264
    v_mfma_f32_32x32x16_bf16 v[64:79], v[160:163], v[164:167], v[64:79]
    v_mfma_f32_32x32x16_bf16 v[80:95], v[168:171], v[164:167], v[80:95]
    v_mfma_f32_32x32x16_bf16 v[184:199], v[160:163], v[172:175], v[184:199]
    v_mfma_f32_32x32x16_bf16 v[200:215], v[168:171], v[172:175], v[200:215]
    s_waitcnt lgkmcnt(0)
    v_mfma_f32_32x32x16_bf16 v[64:79], v[112:115], v[116:119], v[64:79]
    ds_read_b64_tr_b16 v[144:145], v6 offset:12288
    ds_read_b64_tr_b16 v[146:147], v6 offset:13312
    ds_read_b64_tr_b16 v[148:149], v10 offset:4096
    ds_read_b64_tr_b16 v[150:151], v10 offset:5120
    v_mfma_f32_32x32x16_bf16 v[80:95], v[120:123], v[116:119], v[80:95]
    ds_read_b64_tr_b16 v[152:153], v6 offset:20480
    ds_read_b64_tr_b16 v[154:155], v6 offset:21504
    ds_read_b64_tr_b16 v[156:157], v10 offset:12288
    ds_read_b64_tr_b16 v[158:159], v10 offset:13312
    v_mfma_f32_32x32x16_bf16 v[184:199], v[112:115], v[124:127], v[184:199]
    ds_read_b64_tr_b16 v[160:161], v6 offset:14336
    ds_read_b64_tr_b16 v[162:163], v6 offset:15360
    ds_read_b64_tr_b16 v[164:165], v10 offset:6144
    ds_read_b64_tr_b16 v[166:167], v10 offset:7168
    v_mfma_f32_32x32x16_bf16 v[200:215], v[120:123], v[124:127], v[200:215]
    ds_read_b64_tr_b16 v[168:169], v6 offset:22528
    ds_read_b64_tr_b16 v[170:171], v6 offset:23552
    ds_read_b64_tr_b16 v[172:173], v10 offset:14336
    ds_read_b64_tr_b16 v[174:175], v10 offset:15360
    v_mfma_f32_32x32x16_bf16 v[64:79], v[128:131], v[132:135], v[64:79]
    v_mfma_f32_32x32x16_bf16 v[80:95], v[136:139], v[132:135], v[80:95]
    v_mfma_f32_32x32x16_bf16 v[184:199], v[128:131], v[140:143], v[184:199]
    v_mfma_f32_32x32x16_bf16 v[200:215], v[136:139], v[140:143], v[200:215]
    s_waitcnt lgkmcnt(0)
    s_barrier
    v_mfma_f32_32x32x16_bf16 v[64:79], v[144:147], v[148:151], v[64:79]
    ds_read_b64_tr_b16 v[112:113], v4 offset:16384
    ds_read_b64_tr_b16 v[114:115], v4 offset:17408
    ds_read_b64_tr_b16 v[116:117], v10 offset:32768
    ds_read_b64_tr_b16 v[118:119], v10 offset:33792
    v_mfma_f32_32x32x16_bf16 v[80:95], v[152:155], v[148:151], v[80:95]
    ds_read_b64_tr_b16 v[120:121], v4 offset:24576
    ds_read_b64_tr_b16 v[122:123], v4 offset:25600
    ds_read_b64_tr_b16 v[124:125], v10 offset:40960
    ds_read_b64_tr_b16 v[126:127], v10 offset:41984
    v_mfma_f32_32x32x16_bf16 v[184:199], v[144:147], v[156:159], v[184:199]
    ds_read_b64_tr_b16 v[128:129], v4 offset:18432
    ds_read_b64_tr_b16 v[130:131], v4 offset:19456
    ds_read_b64_tr_b16 v[132:133], v10 offset:34816
    ds_read_b64_tr_b16 v[134:135], v10 offset:35840
    v_mfma_f32_32x32x16_bf16 v[200:215], v[152:155], v[156:159], v[200:215]
    ds_read_b64_tr_b16 v[136:137], v4 offset:26624
    ds_read_b64_tr_b16 v[138:139], v4 offset:27648
    ds_read_b64_tr_b16 v[140:141], v10 offset:43008
    ds_read_b64_tr_b16 v[142:143], v10 offset:44032
    v_mfma_f32_32x32x16_bf16 v[64:79], v[160:163], v[164:167], v[64:79]
    v_mfma_f32_32x32x16_bf16 v[80:95], v[168:171], v[164:167], v[80:95]
    v_mfma_f32_32x32x16_bf16 v[184:199], v[160:163], v[172:175], v[184:199]
    v_mfma_f32_32x32x16_bf16 v[200:215], v[168:171], v[172:175], v[200:215]
    s_waitcnt lgkmcnt(0)
    v_mfma_f32_32x32x16_bf16 v[64:79], v[112:115], v[116:119], v[64:79]
    ds_read_b64_tr_b16 v[144:145], v4 offset:20480
    ds_read_b64_tr_b16 v[146:147], v4 offset:21504
    ds_read_b64_tr_b16 v[148:149], v10 offset:36864
    ds_read_b64_tr_b16 v[150:151], v10 offset:37888
    v_mfma_f32_32x32x16_bf16 v[80:95], v[120:123], v[116:119], v[80:95]
    ds_read_b64_tr_b16 v[152:153], v4 offset:28672
    ds_read_b64_tr_b16 v[154:155], v4 offset:29696
    ds_read_b64_tr_b16 v[156:157], v10 offset:45056
    ds_read_b64_tr_b16 v[158:159], v10 offset:46080
    v_mfma_f32_32x32x16_bf16 v[184:199], v[112:115], v[124:127], v[184:199]
    ds_read_b64_tr_b16 v[160:161], v4 offset:22528
    ds_read_b64_tr_b16 v[162:163], v4 offset:23552
    ds_read_b64_tr_b16 v[164:165], v10 offset:38912
    ds_read_b64_tr_b16 v[166:167], v10 offset:39936
    v_mfma_f32_32x32x16_bf16 v[200:215], v[120:123], v[124:127], v[200:215]
    ds_read_b64_tr_b16 v[168:169], v4 offset:30720
    ds_read_b64_tr_b16 v[170:171], v4 offset:31744
    ds_read_b64_tr_b16 v[172:173], v10 offset:47104
    ds_read_b64_tr_b16 v[174:175], v10 offset:48128
    v_mfma_f32_32x32x16_bf16 v[64:79], v[128:131], v[132:135], v[64:79]
    v_mfma_f32_32x32x16_bf16 v[80:95], v[136:139], v[132:135], v[80:95]
    v_mfma_f32_32x32x16_bf16 v[184:199], v[128:131], v[140:143], v[184:199]
    v_mfma_f32_32x32x16_bf16 v[200:215], v[136:139], v[140:143], v[200:215]
    s_waitcnt lgkmcnt(0)
    s_barrier
    v_mfma_f32_32x32x16_bf16 v[64:79], v[144:147], v[148:151], v[64:79]
    ds_read_b64_tr_b16 v[112:113], v4 offset:49152
    ds_read_b64_tr_b16 v[114:115], v4 offset:50176
    ds_read_b64_tr_b16 v[116:117], v11 offset:0
    ds_read_b64_tr_b16 v[118:119], v11 offset:1024
    v_mfma_f32_32x32x16_bf16 v[80:95], v[152:155], v[148:151], v[80:95]
    ds_read_b64_tr_b16 v[120:121], v4 offset:57344
    ds_read_b64_tr_b16 v[122:123], v4 offset:58368
    ds_read_b64_tr_b16 v[124:125], v11 offset:8192
    ds_read_b64_tr_b16 v[126:127], v11 offset:9216
    v_mfma_f32_32x32x16_bf16 v[184:199], v[144:147], v[156:159], v[184:199]
    ds_read_b64_tr_b16 v[128:129], v4 offset:51200
    ds_read_b64_tr_b16 v[130:131], v4 offset:52224
    ds_read_b64_tr_b16 v[132:133], v11 offset:2048
    ds_read_b64_tr_b16 v[134:135], v11 offset:3072
    v_mfma_f32_32x32x16_bf16 v[200:215], v[152:155], v[156:159], v[200:215]
    ds_read_b64_tr_b16 v[136:137], v4 offset:59392
    ds_read_b64_tr_b16 v[138:139], v4 offset:60416
    ds_read_b64_tr_b16 v[140:141], v11 offset:10240
    ds_read_b64_tr_b16 v[142:143], v11 offset:11264
    v_mfma_f32_32x32x16_bf16 v[64:79], v[160:163], v[164:167], v[64:79]
    v_mfma_f32_32x32x16_bf16 v[80:95], v[168:171], v[164:167], v[80:95]
    v_mfma_f32_32x32x16_bf16 v[184:199], v[160:163], v[172:175], v[184:199]
    v_mfma_f32_32x32x16_bf16 v[200:215], v[168:171], v[172:175], v[200:215]
    s_waitcnt lgkmcnt(0)
    v_mfma_f32_32x32x16_bf16 v[64:79], v[112:115], v[116:119], v[64:79]
    ds_read_b64_tr_b16 v[144:145], v4 offset:53248
    ds_read_b64_tr_b16 v[146:147], v4 offset:54272
    ds_read_b64_tr_b16 v[148:149], v11 offset:4096
    ds_read_b64_tr_b16 v[150:151], v11 offset:5120
    v_mfma_f32_32x32x16_bf16 v[80:95], v[120:123], v[116:119], v[80:95]
    ds_read_b64_tr_b16 v[152:153], v4 offset:61440
    ds_read_b64_tr_b16 v[154:155], v4 offset:62464
    ds_read_b64_tr_b16 v[156:157], v11 offset:12288
    ds_read_b64_tr_b16 v[158:159], v11 offset:13312
    v_mfma_f32_32x32x16_bf16 v[184:199], v[112:115], v[124:127], v[184:199]
    ds_read_b64_tr_b16 v[160:161], v4 offset:55296
    ds_read_b64_tr_b16 v[162:163], v4 offset:56320
    ds_read_b64_tr_b16 v[164:165], v11 offset:6144
    ds_read_b64_tr_b16 v[166:167], v11 offset:7168
    v_mfma_f32_32x32x16_bf16 v[200:215], v[120:123], v[124:127], v[200:215]
    ds_read_b64_tr_b16 v[168:169], v4 offset:63488
    ds_read_b64_tr_b16 v[170:171], v4 offset:64512
    ds_read_b64_tr_b16 v[172:173], v11 offset:14336
    ds_read_b64_tr_b16 v[174:175], v11 offset:15360
    v_mfma_f32_32x32x16_bf16 v[64:79], v[128:131], v[132:135], v[64:79]
    v_mfma_f32_32x32x16_bf16 v[80:95], v[136:139], v[132:135], v[80:95]
    v_mfma_f32_32x32x16_bf16 v[184:199], v[128:131], v[140:143], v[184:199]
    v_mfma_f32_32x32x16_bf16 v[200:215], v[136:139], v[140:143], v[200:215]
    s_waitcnt lgkmcnt(0)
    s_barrier
    v_mfma_f32_32x32x16_bf16 v[64:79], v[144:147], v[148:151], v[64:79]
    ds_read_b64_tr_b16 v[112:113], v5 offset:16384
    ds_read_b64_tr_b16 v[114:115], v5 offset:17408
    ds_read_b64_tr_b16 v[116:117], v11 offset:32768
    ds_read_b64_tr_b16 v[118:119], v11 offset:33792
    v_mfma_f32_32x32x16_bf16 v[80:95], v[152:155], v[148:151], v[80:95]
    ds_read_b64_tr_b16 v[120:121], v5 offset:24576
    ds_read_b64_tr_b16 v[122:123], v5 offset:25600
    ds_read_b64_tr_b16 v[124:125], v11 offset:40960
    ds_read_b64_tr_b16 v[126:127], v11 offset:41984
    v_mfma_f32_32x32x16_bf16 v[184:199], v[144:147], v[156:159], v[184:199]
    ds_read_b64_tr_b16 v[128:129], v5 offset:18432
    ds_read_b64_tr_b16 v[130:131], v5 offset:19456
    ds_read_b64_tr_b16 v[132:133], v11 offset:34816
    ds_read_b64_tr_b16 v[134:135], v11 offset:35840
    v_mfma_f32_32x32x16_bf16 v[200:215], v[152:155], v[156:159], v[200:215]
    ds_read_b64_tr_b16 v[136:137], v5 offset:26624
    ds_read_b64_tr_b16 v[138:139], v5 offset:27648
    ds_read_b64_tr_b16 v[140:141], v11 offset:43008
    ds_read_b64_tr_b16 v[142:143], v11 offset:44032
    v_mfma_f32_32x32x16_bf16 v[64:79], v[160:163], v[164:167], v[64:79]
    v_mfma_f32_32x32x16_bf16 v[80:95], v[168:171], v[164:167], v[80:95]
    v_mfma_f32_32x32x16_bf16 v[184:199], v[160:163], v[172:175], v[184:199]
    v_mfma_f32_32x32x16_bf16 v[200:215], v[168:171], v[172:175], v[200:215]
    s_waitcnt lgkmcnt(0)
    v_mfma_f32_32x32x16_bf16 v[64:79], v[112:115], v[116:119], v[64:79]
    ds_read_b64_tr_b16 v[144:145], v5 offset:20480
    ds_read_b64_tr_b16 v[146:147], v5 offset:21504
    ds_read_b64_tr_b16 v[148:149], v11 offset:36864
    ds_read_b64_tr_b16 v[150:151], v11 offset:37888
    v_mfma_f32_32x32x16_bf16 v[80:95], v[120:123], v[116:119], v[80:95]
    ds_read_b64_tr_b16 v[152:153], v5 offset:28672
    ds_read_b64_tr_b16 v[154:155], v5 offset:29696
    ds_read_b64_tr_b16 v[156:157], v11 offset:45056
    ds_read_b64_tr_b16 v[158:159], v11 offset:46080
    v_mfma_f32_32x32x16_bf16 v[184:199], v[112:115], v[124:127], v[184:199]
    ds_read_b64_tr_b16 v[160:161], v5 offset:22528
    ds_read_b64_tr_b16 v[162:163], v5 offset:23552
    ds_read_b64_tr_b16 v[164:165], v11 offset:38912
    ds_read_b64_tr_b16 v[166:167], v11 offset:39936
    v_mfma_f32_32x32x16_bf16 v[200:215], v[120:123], v[124:127], v[200:215]
    ds_read_b64_tr_b16 v[168:169], v5 offset:30720
    ds_read_b64_tr_b16 v[170:171], v5 offset:31744
    ds_read_b64_tr_b16 v[172:173], v11 offset:47104
    ds_read_b64_tr_b16 v[174:175], v11 offset:48128
    v_mfma_f32_32x32x16_bf16 v[64:79], v[128:131], v[132:135], v[64:79]
    v_mfma_f32_32x32x16_bf16 v[80:95], v[136:139], v[132:135], v[80:95]
    v_mfma_f32_32x32x16_bf16 v[184:199], v[128:131], v[140:143], v[184:199]
    v_mfma_f32_32x32x16_bf16 v[200:215], v[136:139], v[140:143], v[200:215]
    s_waitcnt lgkmcnt(0)
    s_barrier
    v_mfma_f32_32x32x16_bf16 v[64:79], v[144:147], v[148:151], v[64:79]
    ds_read_b64_tr_b16 v[112:113], v5 offset:49152
    ds_read_b64_tr_b16 v[114:115], v5 offset:50176
    ds_read_b64_tr_b16 v[116:117], v12 offset:0
    ds_read_b64_tr_b16 v[118:119], v12 offset:1024
    v_mfma_f32_32x32x16_bf16 v[80:95], v[152:155], v[148:151], v[80:95]
    ds_read_b64_tr_b16 v[120:121], v5 offset:57344
    ds_read_b64_tr_b16 v[122:123], v5 offset:58368
    ds_read_b64_tr_b16 v[124:125], v12 offset:8192
    ds_read_b64_tr_b16 v[126:127], v12 offset:9216
    v_mfma_f32_32x32x16_bf16 v[184:199], v[144:147], v[156:159], v[184:199]
    ds_read_b64_tr_b16 v[128:129], v5 offset:51200
    ds_read_b64_tr_b16 v[130:131], v5 offset:52224
    ds_read_b64_tr_b16 v[132:133], v12 offset:2048
    ds_read_b64_tr_b16 v[134:135], v12 offset:3072
    v_mfma_f32_32x32x16_bf16 v[200:215], v[152:155], v[156:159], v[200:215]
    ds_read_b64_tr_b16 v[136:137], v5 offset:59392
    ds_read_b64_tr_b16 v[138:139], v5 offset:60416
    ds_read_b64_tr_b16 v[140:141], v12 offset:10240
    ds_read_b64_tr_b16 v[142:143], v12 offset:11264
    v_mfma_f32_32x32x16_bf16 v[64:79], v[160:163], v[164:167], v[64:79]
    v_mfma_f32_32x32x16_bf16 v[80:95], v[168:171], v[164:167], v[80:95]
    v_mfma_f32_32x32x16_bf16 v[184:199], v[160:163], v[172:175], v[184:199]
    v_mfma_f32_32x32x16_bf16 v[200:215], v[168:171], v[172:175], v[200:215]
    s_waitcnt lgkmcnt(0)
    v_mfma_f32_32x32x16_bf16 v[64:79], v[112:115], v[116:119], v[64:79]
    ds_read_b64_tr_b16 v[144:145], v5 offset:53248
    ds_read_b64_tr_b16 v[146:147], v5 offset:54272
    ds_read_b64_tr_b16 v[148:149], v12 offset:4096
    ds_read_b64_tr_b16 v[150:151], v12 offset:5120
    v_mfma_f32_32x32x16_bf16 v[80:95], v[120:123], v[116:119], v[80:95]
    ds_read_b64_tr_b16 v[152:153], v5 offset:61440
    ds_read_b64_tr_b16 v[154:155], v5 offset:62464
    ds_read_b64_tr_b16 v[156:157], v12 offset:12288
    ds_read_b64_tr_b16 v[158:159], v12 offset:13312
    v_mfma_f32_32x32x16_bf16 v[184:199], v[112:115], v[124:127], v[184:199]
    ds_read_b64_tr_b16 v[160:161], v5 offset:55296
    ds_read_b64_tr_b16 v[162:163], v5 offset:56320
    ds_read_b64_tr_b16 v[164:165], v12 offset:6144
    ds_read_b64_tr_b16 v[166:167], v12 offset:7168
    v_mfma_f32_32x32x16_bf16 v[200:215], v[120:123], v[124:127], v[200:215]
    ds_read_b64_tr_b16 v[168:169], v5 offset:63488
    ds_read_b64_tr_b16 v[170:171], v5 offset:64512
    ds_read_b64_tr_b16 v[172:173], v12 offset:14336
    ds_read_b64_tr_b16 v[174:175], v12 offset:15360
    v_mfma_f32_32x32x16_bf16 v[64:79], v[128:131], v[132:135], v[64:79]
    v_mfma_f32_32x32x16_bf16 v[80:95], v[136:139], v[132:135], v[80:95]
    v_mfma_f32_32x32x16_bf16 v[184:199], v[128:131], v[140:143], v[184:199]
    v_mfma_f32_32x32x16_bf16 v[200:215], v[136:139], v[140:143], v[200:215]
    s_waitcnt lgkmcnt(0)
    s_barrier
    v_mfma_f32_32x32x16_bf16 v[64:79], v[144:147], v[148:151], v[64:79]
    ds_read_b64_tr_b16 v[112:113], v6 offset:16384
    ds_read_b64_tr_b16 v[114:115], v6 offset:17408
    ds_read_b64_tr_b16 v[116:117], v10 offset:8192
    ds_read_b64_tr_b16 v[118:119], v10 offset:9216
    v_mfma_f32_32x32x16_bf16 v[80:95], v[152:155], v[148:151], v[80:95]
    ds_read_b64_tr_b16 v[120:121], v4 offset:0
    ds_read_b64_tr_b16 v[122:123], v4 offset:1024
    ds_read_b64_tr_b16 v[124:125], v10 offset:16384
    ds_read_b64_tr_b16 v[126:127], v10 offset:17408
    v_mfma_f32_32x32x16_bf16 v[184:199], v[144:147], v[156:159], v[184:199]
    ds_read_b64_tr_b16 v[128:129], v6 offset:18432
    ds_read_b64_tr_b16 v[130:131], v6 offset:19456
    ds_read_b64_tr_b16 v[132:133], v10 offset:10240
    ds_read_b64_tr_b16 v[134:135], v10 offset:11264
    v_mfma_f32_32x32x16_bf16 v[200:215], v[152:155], v[156:159], v[200:215]
    ds_read_b64_tr_b16 v[136:137], v4 offset:2048
    ds_read_b64_tr_b16 v[138:139], v4 offset:3072
    ds_read_b64_tr_b16 v[140:141], v10 offset:18432
    ds_read_b64_tr_b16 v[142:143], v10 offset:19456
    v_mfma_f32_32x32x16_bf16 v[64:79], v[160:163], v[164:167], v[64:79]
    v_mfma_f32_32x32x16_bf16 v[80:95], v[168:171], v[164:167], v[80:95]
    v_mfma_f32_32x32x16_bf16 v[184:199], v[160:163], v[172:175], v[184:199]
    v_mfma_f32_32x32x16_bf16 v[200:215], v[168:171], v[172:175], v[200:215]
    s_waitcnt lgkmcnt(0)
    v_mfma_f32_32x32x16_bf16 v[64:79], v[112:115], v[116:119], v[64:79]
    ds_read_b64_tr_b16 v[144:145], v6 offset:20480
    ds_read_b64_tr_b16 v[146:147], v6 offset:21504
    ds_read_b64_tr_b16 v[148:149], v10 offset:12288
    ds_read_b64_tr_b16 v[150:151], v10 offset:13312
    v_mfma_f32_32x32x16_bf16 v[80:95], v[120:123], v[116:119], v[80:95]
    ds_read_b64_tr_b16 v[152:153], v4 offset:4096
    ds_read_b64_tr_b16 v[154:155], v4 offset:5120
    ds_read_b64_tr_b16 v[156:157], v10 offset:20480
    ds_read_b64_tr_b16 v[158:159], v10 offset:21504
    v_mfma_f32_32x32x16_bf16 v[184:199], v[112:115], v[124:127], v[184:199]
    ds_read_b64_tr_b16 v[160:161], v6 offset:22528
    ds_read_b64_tr_b16 v[162:163], v6 offset:23552
    ds_read_b64_tr_b16 v[164:165], v10 offset:14336
    ds_read_b64_tr_b16 v[166:167], v10 offset:15360
    v_mfma_f32_32x32x16_bf16 v[200:215], v[120:123], v[124:127], v[200:215]
    ds_read_b64_tr_b16 v[168:169], v4 offset:6144
    ds_read_b64_tr_b16 v[170:171], v4 offset:7168
    ds_read_b64_tr_b16 v[172:173], v10 offset:22528
    ds_read_b64_tr_b16 v[174:175], v10 offset:23552
    v_mfma_f32_32x32x16_bf16 v[64:79], v[128:131], v[132:135], v[64:79]
    v_mfma_f32_32x32x16_bf16 v[80:95], v[136:139], v[132:135], v[80:95]
    v_mfma_f32_32x32x16_bf16 v[184:199], v[128:131], v[140:143], v[184:199]
    v_mfma_f32_32x32x16_bf16 v[200:215], v[136:139], v[140:143], v[200:215]
    s_waitcnt lgkmcnt(0)
    s_barrier
    v_mfma_f32_32x32x16_bf16 v[64:79], v[144:147], v[148:151], v[64:79]
    ds_read_b64_tr_b16 v[112:113], v4 offset:24576
    ds_read_b64_tr_b16 v[114:115], v4 offset:25600
    ds_read_b64_tr_b16 v[116:117], v10 offset:40960
    ds_read_b64_tr_b16 v[118:119], v10 offset:41984
    v_mfma_f32_32x32x16_bf16 v[80:95], v[152:155], v[148:151], v[80:95]
    ds_read_b64_tr_b16 v[120:121], v4 offset:32768
    ds_read_b64_tr_b16 v[122:123], v4 offset:33792
    ds_read_b64_tr_b16 v[124:125], v10 offset:49152
    ds_read_b64_tr_b16 v[126:127], v10 offset:50176
    v_mfma_f32_32x32x16_bf16 v[184:199], v[144:147], v[156:159], v[184:199]
    ds_read_b64_tr_b16 v[128:129], v4 offset:26624
    ds_read_b64_tr_b16 v[130:131], v4 offset:27648
    ds_read_b64_tr_b16 v[132:133], v10 offset:43008
    ds_read_b64_tr_b16 v[134:135], v10 offset:44032
    v_mfma_f32_32x32x16_bf16 v[200:215], v[152:155], v[156:159], v[200:215]
    ds_read_b64_tr_b16 v[136:137], v4 offset:34816
    ds_read_b64_tr_b16 v[138:139], v4 offset:35840
    ds_read_b64_tr_b16 v[140:141], v10 offset:51200
    ds_read_b64_tr_b16 v[142:143], v10 offset:52224
    v_mfma_f32_32x32x16_bf16 v[64:79], v[160:163], v[164:167], v[64:79]
    v_mfma_f32_32x32x16_bf16 v[80:95], v[168:171], v[164:167], v[80:95]
    v_mfma_f32_32x32x16_bf16 v[184:199], v[160:163], v[172:175], v[184:199]
    v_mfma_f32_32x32x16_bf16 v[200:215], v[168:171], v[172:175], v[200:215]
    s_waitcnt lgkmcnt(0)
    v_mfma_f32_32x32x16_bf16 v[64:79], v[112:115], v[116:119], v[64:79]
    ds_read_b64_tr_b16 v[144:145], v4 offset:28672
    ds_read_b64_tr_b16 v[146:147], v4 offset:29696
    ds_read_b64_tr_b16 v[148:149], v10 offset:45056
    ds_read_b64_tr_b16 v[150:151], v10 offset:46080
    v_mfma_f32_32x32x16_bf16 v[80:95], v[120:123], v[116:119], v[80:95]
    ds_read_b64_tr_b16 v[152:153], v4 offset:36864
    ds_read_b64_tr_b16 v[154:155], v4 offset:37888
    ds_read_b64_tr_b16 v[156:157], v10 offset:53248
    ds_read_b64_tr_b16 v[158:159], v10 offset:54272
    v_mfma_f32_32x32x16_bf16 v[184:199], v[112:115], v[124:127], v[184:199]
    ds_read_b64_tr_b16 v[160:161], v4 offset:30720
    ds_read_b64_tr_b16 v[162:163], v4 offset:31744
    ds_read_b64_tr_b16 v[164:165], v10 offset:47104
    ds_read_b64_tr_b16 v[166:167], v10 offset:48128
    v_mfma_f32_32x32x16_bf16 v[200:215], v[120:123], v[124:127], v[200:215]
    ds_read_b64_tr_b16 v[168:169], v4 offset:38912
    ds_read_b64_tr_b16 v[170:171], v4 offset:39936
    ds_read_b64_tr_b16 v[172:173], v10 offset:55296
    ds_read_b64_tr_b16 v[174:175], v10 offset:56320
    v_mfma_f32_32x32x16_bf16 v[64:79], v[128:131], v[132:135], v[64:79]
    v_mfma_f32_32x32x16_bf16 v[80:95], v[136:139], v[132:135], v[80:95]
    v_mfma_f32_32x32x16_bf16 v[184:199], v[128:131], v[140:143], v[184:199]
    v_mfma_f32_32x32x16_bf16 v[200:215], v[136:139], v[140:143], v[200:215]
    s_waitcnt lgkmcnt(0)
    v_mfma_f32_32x32x16_bf16 v[80:95], v[152:155], v[148:151], v[80:95]
    s_xor_b32 s61, s90, 1
    s_lshl_b32 s60, s89, 2
    s_add_u32 s60, s60, s61
    v_mfma_f32_32x32x16_bf16 v[184:199], v[144:147], v[156:159], v[184:199]
    s_mul_i32 s60, s60, 24576
    s_add_u32 s66, s60, 8388608
    s_xor_b32 s61, s90, 2
    v_mfma_f32_32x32x16_bf16 v[200:215], v[152:155], v[156:159], v[200:215]
    s_lshl_b32 s60, s89, 2
    s_add_u32 s60, s60, s61
    s_mul_i32 s60, s60, 24576
    v_mfma_f32_32x32x16_bf16 v[64:79], v[144:147], v[148:151], v[64:79]
    s_add_u32 s67, s60, 8396800
    s_xor_b32 s61, s90, 3
    s_lshl_b32 s60, s89, 2
    v_mfma_f32_32x32x16_bf16 v[80:95], v[168:171], v[164:167], v[80:95]
    s_add_u32 s60, s60, s61
    s_mul_i32 s60, s60, 24576
    s_add_u32 s68, s60, 8404992
    v_mfma_f32_32x32x16_bf16 v[184:199], v[160:163], v[172:175], v[184:199]
    s_mul_i32 s60, s3, 2048
    v_add_u32 v47, s60, v46
    v_mfma_f32_32x32x16_bf16 v[200:215], v[168:171], v[172:175], v[200:215]
    v_mfma_f32_32x32x16_bf16 v[64:79], v[160:163], v[164:167], v[64:79]
    s_nop 3
    v_cvt_pk_bf16_f32 v80, v80, v81
    v_cvt_pk_bf16_f32 v81, v82, v83
    v_cvt_pk_bf16_f32 v82, v84, v85
    v_cvt_pk_bf16_f32 v83, v86, v87
    v_cvt_pk_bf16_f32 v84, v88, v89
    v_cvt_pk_bf16_f32 v85, v90, v91
    v_cvt_pk_bf16_f32 v86, v92, v93
    v_cvt_pk_bf16_f32 v87, v94, v95
    buffer_store_dwordx4 v[80:83], v47, s[4:7], s66 offen offset:0 sc1
    buffer_store_dwordx4 v[84:87], v47, s[4:7], s66 offen offset:1024 sc1
    v_cvt_pk_bf16_f32 v184, v184, v185
    v_cvt_pk_bf16_f32 v185, v186, v187
    v_cvt_pk_bf16_f32 v186, v188, v189
    v_cvt_pk_bf16_f32 v187, v190, v191
    v_cvt_pk_bf16_f32 v188, v192, v193
    v_cvt_pk_bf16_f32 v189, v194, v195
    v_cvt_pk_bf16_f32 v190, v196, v197
    v_cvt_pk_bf16_f32 v191, v198, v199
    buffer_store_dwordx4 v[184:187], v47, s[4:7], s67 offen offset:0 sc1
    buffer_store_dwordx4 v[188:191], v47, s[4:7], s67 offen offset:1024 sc1
    v_cvt_pk_bf16_f32 v200, v200, v201
    v_cvt_pk_bf16_f32 v201, v202, v203
    v_cvt_pk_bf16_f32 v202, v204, v205
    v_cvt_pk_bf16_f32 v203, v206, v207
    v_cvt_pk_bf16_f32 v204, v208, v209
    v_cvt_pk_bf16_f32 v205, v210, v211
    v_cvt_pk_bf16_f32 v206, v212, v213
    v_cvt_pk_bf16_f32 v207, v214, v215
    buffer_store_dwordx4 v[200:203], v47, s[4:7], s68 offen offset:0 sc1
    buffer_store_dwordx4 v[204:207], v47, s[4:7], s68 offen offset:1024 sc1
    s_barrier
    buffer_load_dwordx4 v[120:123], v46, s[4:7], s70 offen sc1
    s_mov_b32 s60, 0x35c1a2a0
    s_mov_b32 s61, 0x3f317218
    v_pk_fma_f32 v[48:49], v[176:177], v[96:97], v[48:49] op_sel_hi:[0,1,1] neg_lo:[1,0,0] neg_hi:[1,0,0]
    v_pk_fma_f32 v[50:51], v[176:177], v[98:99], v[50:51] op_sel_hi:[0,1,1] neg_lo:[1,0,0] neg_hi:[1,0,0]
    v_pk_fma_f32 v[48:49], v[48:49], v[176:177], s[60:61] op_sel:[0,1,0] op_sel_hi:[1,1,0]
    v_pk_fma_f32 v[50:51], v[50:51], v[176:177], s[60:61] op_sel:[0,1,0] op_sel_hi:[1,1,0]
    v_exp_f32_e64 v128, v48 clamp
    v_exp_f32_e64 v129, v49 clamp
    v_exp_f32_e64 v130, v50 clamp
    v_exp_f32_e64 v131, v51 clamp
    v_max_f32 v48, s60, v48
    v_max_f32 v49, s60, v49
    v_max_f32 v50, s60, v50
    v_max_f32 v51, s60, v51
    v_pk_fma_f32 v[48:49], v[48:49], s[60:61], v[128:129] op_sel:[0,1,0] op_sel_hi:[1,1,1]
    v_pk_fma_f32 v[50:51], v[50:51], s[60:61], v[130:131] op_sel:[0,1,0] op_sel_hi:[1,1,1]
    v_cvt_pk_bf16_f32 v28, v48, v49
    v_cvt_pk_bf16_f32 v29, v50, v51
    v_pk_fma_f32 v[52:53], v[178:179], v[96:97], v[52:53] op_sel_hi:[0,1,1] neg_lo:[1,0,0] neg_hi:[1,0,0]
    v_pk_fma_f32 v[54:55], v[178:179], v[98:99], v[54:55] op_sel_hi:[0,1,1] neg_lo:[1,0,0] neg_hi:[1,0,0]
    v_pk_fma_f32 v[52:53], v[52:53], v[178:179], s[60:61] op_sel:[0,1,0] op_sel_hi:[1,1,0]
    v_pk_fma_f32 v[54:55], v[54:55], v[178:179], s[60:61] op_sel:[0,1,0] op_sel_hi:[1,1,0]
    v_exp_f32_e64 v128, v52 clamp
    v_exp_f32_e64 v129, v53 clamp
    v_exp_f32_e64 v130, v54 clamp
    v_exp_f32_e64 v131, v55 clamp
    v_max_f32 v52, s60, v52
    v_max_f32 v53, s60, v53
    v_max_f32 v54, s60, v54
    v_max_f32 v55, s60, v55
    v_pk_fma_f32 v[52:53], v[52:53], s[60:61], v[128:129] op_sel:[0,1,0] op_sel_hi:[1,1,1]
    v_pk_fma_f32 v[54:55], v[54:55], s[60:61], v[130:131] op_sel:[0,1,0] op_sel_hi:[1,1,1]
    v_cvt_pk_bf16_f32 v30, v52, v53
    v_cvt_pk_bf16_f32 v31, v54, v55
    v_pk_fma_f32 v[56:57], v[180:181], v[96:97], v[56:57] op_sel_hi:[0,1,1] neg_lo:[1,0,0] neg_hi:[1,0,0]
    v_pk_fma_f32 v[58:59], v[180:181], v[98:99], v[58:59] op_sel_hi:[0,1,1] neg_lo:[1,0,0] neg_hi:[1,0,0]
    v_pk_fma_f32 v[56:57], v[56:57], v[180:181], s[60:61] op_sel:[0,1,0] op_sel_hi:[1,1,0]
    v_pk_fma_f32 v[58:59], v[58:59], v[180:181], s[60:61] op_sel:[0,1,0] op_sel_hi:[1,1,0]
    v_exp_f32_e64 v128, v56 clamp
    v_exp_f32_e64 v129, v57 clamp
    v_exp_f32_e64 v130, v58 clamp
    v_exp_f32_e64 v131, v59 clamp
    v_max_f32 v56, s60, v56
    v_max_f32 v57, s60, v57
    v_max_f32 v58, s60, v58
    v_max_f32 v59, s60, v59
    v_pk_fma_f32 v[56:57], v[56:57], s[60:61], v[128:129] op_sel:[0,1,0] op_sel_hi:[1,1,1]
    v_pk_fma_f32 v[58:59], v[58:59], s[60:61], v[130:131] op_sel:[0,1,0] op_sel_hi:[1,1,1]
    v_cvt_pk_bf16_f32 v32, v56, v57
    v_cvt_pk_bf16_f32 v33, v58, v59
    v_pk_fma_f32 v[60:61], v[182:183], v[96:97], v[60:61] op_sel_hi:[0,1,1] neg_lo:[1,0,0] neg_hi:[1,0,0]
    v_pk_fma_f32 v[62:63], v[182:183], v[98:99], v[62:63] op_sel_hi:[0,1,1] neg_lo:[1,0,0] neg_hi:[1,0,0]
    v_pk_fma_f32 v[60:61], v[60:61], v[182:183], s[60:61] op_sel:[0,1,0] op_sel_hi:[1,1,0]
    v_pk_fma_f32 v[62:63], v[62:63], v[182:183], s[60:61] op_sel:[0,1,0] op_sel_hi:[1,1,0]
    v_exp_f32_e64 v128, v60 clamp
    v_exp_f32_e64 v129, v61 clamp
    v_exp_f32_e64 v130, v62 clamp
    v_exp_f32_e64 v131, v63 clamp
    v_max_f32 v60, s60, v60
    v_max_f32 v61, s60, v61
    v_max_f32 v62, s60, v62
    v_max_f32 v63, s60, v63
    v_pk_fma_f32 v[60:61], v[60:61], s[60:61], v[128:129] op_sel:[0,1,0] op_sel_hi:[1,1,1]
    v_pk_fma_f32 v[62:63], v[62:63], s[60:61], v[130:131] op_sel:[0,1,0] op_sel_hi:[1,1,1]
    v_cvt_pk_bf16_f32 v34, v60, v61
    v_cvt_pk_bf16_f32 v35, v62, v63
    s_lshl_b32 s60, s89, 10
    s_add_u32 s60, s60, 196608
    s_lshl_b32 s67, s90, 8
    s_add_u32 s67, s67, s60
    s_xor_b32 s49, s67, 256
    s_mov_b32 s46, 1
    s_xor_b32 s50, s67, 512
    s_mov_b32 s47, 1
    s_xor_b32 s51, s67, 768
    s_mov_b32 s48, 1
    s_waitcnt vmcnt(1)
    s_atomic_add s46, s[58:59], s49 glc
    s_atomic_add s47, s[58:59], s50 glc
    s_atomic_add s48, s[58:59], s51 glc
    s_barrier
    v_and_b32 v36, 1, v3
    v_lshlrev_b32 v36, 5, v36
    v_lshl_add_u32 v36, v43, 4, v36
    v_add_lshl_u32 v36, v36, v2, 4
    s_lshl_b32 s60, s34, 16
    s_lshl_b32 s61, s35, 13
    s_add_u32 s60, s60, s61
    s_lshl_b32 s61, s3, 11
    s_add_u32 s60, s60, s61
    s_add_u32 s60, s60, 4194304
    s_mov_b32 s74, 0
    s_waitcnt vmcnt(0)
L_kvchk:
    v_cmp_ne_u32 vcc, s32, v123
    s_cbranch_vccz L_kvok
    s_add_u32 s74, s74, 1
    s_cmp_gt_u32 s74, 20000
    s_cbranch_scc1 L_kvok
    s_sleep 8
    buffer_load_dwordx4 v[120:123], v46, s[4:7], s70 offen sc1
    s_waitcnt vmcnt(0)
    s_branch L_kvchk
L_kvok:
    v_mov_b32_dpp v160, v122 quad_perm:[0,0,0,0] row_mask:0xf bank_mask:0xf
    v_mov_b32_dpp v161, v122 quad_perm:[1,1,1,1] row_mask:0xf bank_mask:0xf
    v_mov_b32_dpp v162, v122 quad_perm:[2,2,2,2] row_mask:0xf bank_mask:0xf
    v_mov_b32_dpp v163, v122 quad_perm:[3,3,3,3] row_mask:0xf bank_mask:0xf
    v_cvt_pk_bf16_f32 v122, v160, v161
    v_cvt_pk_bf16_f32 v123, v162, v163
    s_nop 1
    v_mfma_f32_16x16x16_bf16 v[160:163], v[122:123], v[28:29], 0
    v_mfma_f32_16x16x16_bf16 v[164:167], v[122:123], v[30:31], 0
    v_mfma_f32_16x16x16_bf16 v[168:171], v[122:123], v[32:33], 0
    v_mfma_f32_16x16x16_bf16 v[172:175], v[122:123], v[34:35], 0
    v_mfma_f32_16x16x16_bf16 v[144:147], v[120:121], v[28:29], 0
    v_mfma_f32_16x16x16_bf16 v[148:151], v[120:121], v[30:31], 0
    v_mfma_f32_16x16x16_bf16 v[152:155], v[120:121], v[32:33], 0
    v_mfma_f32_16x16x16_bf16 v[156:159], v[120:121], v[34:35], 0
    s_nop 0
    v_add_f32 v160, 0x358637bd, v160
    v_add_f32 v164, 0x358637bd, v164
    v_add_f32 v168, 0x358637bd, v168
    v_add_f32 v172, 0x358637bd, v172
    v_rcp_f32 v160, v160
    v_rcp_f32 v164, v164
    v_rcp_f32 v168, v168
    v_rcp_f32 v172, v172
    v_pk_mul_f32 v[144:145], v[144:145], v[160:161] op_sel_hi:[1,0]
    v_pk_mul_f32 v[146:147], v[146:147], v[160:161] op_sel_hi:[1,0]
    v_cvt_pk_bf16_f32 v112, v144, v145
    v_cvt_pk_bf16_f32 v113, v146, v147
    v_pk_mul_f32 v[148:149], v[148:149], v[164:165] op_sel_hi:[1,0]
    v_pk_mul_f32 v[150:151], v[150:151], v[164:165] op_sel_hi:[1,0]
    v_cvt_pk_bf16_f32 v114, v148, v149
    v_cvt_pk_bf16_f32 v115, v150, v151
    v_pk_mul_f32 v[152:153], v[152:153], v[168:169] op_sel_hi:[1,0]
    v_pk_mul_f32 v[154:155], v[154:155], v[168:169] op_sel_hi:[1,0]
    v_cvt_pk_bf16_f32 v116, v152, v153
    v_cvt_pk_bf16_f32 v117, v154, v155
    v_pk_mul_f32 v[156:157], v[156:157], v[172:173] op_sel_hi:[1,0]
    v_pk_mul_f32 v[158:159], v[158:159], v[172:173] op_sel_hi:[1,0]
    v_cvt_pk_bf16_f32 v118, v156, v157
    v_cvt_pk_bf16_f32 v119, v158, v159
    v_permlane32_swap_b32 v112, v114
    v_permlane32_swap_b32 v113, v115
    buffer_store_dwordx4 v[112:115], v36, s[4:7], s60 offen offset:0 sc1
    v_permlane32_swap_b32 v116, v118
    v_permlane32_swap_b32 v117, v119
    buffer_store_dwordx4 v[116:119], v36, s[4:7], s60 offen offset:1024 sc1
    s_mov_b32 s68, 0
    s_atomic_add s68, s[58:59], s67 glc
L_cjoin:
    ds_read_b64_tr_b16 v[80:81], v10 offset:57344
    ds_read_b64_tr_b16 v[82:83], v10 offset:58368
    ds_read_b64_tr_b16 v[84:85], v10 offset:59392
    ds_read_b64_tr_b16 v[86:87], v10 offset:60416
    ds_read_b64_tr_b16 v[88:89], v11 offset:0
    ds_read_b64_tr_b16 v[90:91], v11 offset:1024
    ds_read_b64_tr_b16 v[92:93], v11 offset:2048
    ds_read_b64_tr_b16 v[94:95], v11 offset:3072
    ds_read_b64_tr_b16 v[96:97], v11 offset:4096
    ds_read_b64_tr_b16 v[98:99], v11 offset:5120
    ds_read_b64_tr_b16 v[100:101], v11 offset:6144
    ds_read_b64_tr_b16 v[102:103], v11 offset:7168
    ds_read_b64_tr_b16 v[104:105], v11 offset:8192
    ds_read_b64_tr_b16 v[106:107], v11 offset:9216
    ds_read_b64_tr_b16 v[108:109], v11 offset:10240
    ds_read_b64_tr_b16 v[110:111], v11 offset:11264
    ds_read_b64_tr_b16 v[176:177], v11 offset:12288
    ds_read_b64_tr_b16 v[178:179], v11 offset:13312
    ds_read_b64_tr_b16 v[180:181], v11 offset:14336
    ds_read_b64_tr_b16 v[182:183], v11 offset:15360
    ds_read_b64_tr_b16 v[184:185], v11 offset:16384
    ds_read_b64_tr_b16 v[186:187], v11 offset:17408
    ds_read_b64_tr_b16 v[188:189], v11 offset:18432
    ds_read_b64_tr_b16 v[190:191], v11 offset:19456
    ds_read_b64_tr_b16 v[192:193], v11 offset:20480
    ds_read_b64_tr_b16 v[194:195], v11 offset:21504
    ds_read_b64_tr_b16 v[196:197], v11 offset:22528
    ds_read_b64_tr_b16 v[198:199], v11 offset:23552
    ds_read_b64_tr_b16 v[200:201], v11 offset:24576
    ds_read_b64_tr_b16 v[202:203], v11 offset:25600
    ds_read_b64_tr_b16 v[204:205], v11 offset:26624
    ds_read_b64_tr_b16 v[206:207], v11 offset:27648
    ds_read_b64_tr_b16 v[208:209], v11 offset:28672
    ds_read_b64_tr_b16 v[210:211], v11 offset:29696
    ds_read_b64_tr_b16 v[212:213], v11 offset:30720
    ds_read_b64_tr_b16 v[214:215], v11 offset:31744
    ds_read_b64_tr_b16 v[216:217], v11 offset:32768
    ds_read_b64_tr_b16 v[218:219], v11 offset:33792
    ds_read_b64_tr_b16 v[220:221], v11 offset:34816
    ds_read_b64_tr_b16 v[222:223], v11 offset:35840
    ds_read_b64_tr_b16 v[224:225], v11 offset:36864
    ds_read_b64_tr_b16 v[226:227], v11 offset:37888
    ds_read_b64_tr_b16 v[228:229], v11 offset:38912
    ds_read_b64_tr_b16 v[230:231], v11 offset:39936
    ds_read_b64_tr_b16 v[232:233], v11 offset:40960
    ds_read_b64_tr_b16 v[234:235], v11 offset:41984
    ds_read_b64_tr_b16 v[236:237], v11 offset:43008
    ds_read_b64_tr_b16 v[238:239], v11 offset:44032
    ds_read_b64_tr_b16 v[240:241], v11 offset:45056
    ds_read_b64_tr_b16 v[242:243], v11 offset:46080
    ds_read_b64_tr_b16 v[244:245], v11 offset:47104
    ds_read_b64_tr_b16 v[246:247], v11 offset:48128
    s_lshl_b32 s60, s72, 10
    v_add_u32 v7, s60, v46
    s_lshl_b32 s60, s71, 10
    v_add_u32 v13, s60, v46
    v_add_u32 v8, 0x10000, v7
    v_add_u32 v9, 0x20000, v7
    v_add_u32 v14, 0x10000, v13
    v_add_u32 v15, 0x20000, v13
    s_lshl_b32 s60, s89, 2
    s_add_u32 s60, s60, s90
    s_mul_i32 s60, s60, 24576
    s_add_u32 s63, s60, 8388608
    s_mov_b32 s64, 0xbdd2d3e8
    s_mov_b32 s65, 0xc0135761
    s_mul_i32 s62, s88, 22
    s_add_u32 s62, s62, s53
    s_lshl_b32 s62, s62, 13
    s_lshl_b32 s61, s71, 12
    s_add_u32 s62, s62, s61
    s_lshl_b32 s61, s72, 10
    s_add_u32 s62, s62, s61
    s_add_u32 s62, s62, 6291456
    s_waitcnt lgkmcnt(0)
    s_barrier
    s_cmp_eq_u32 s54, 0
    s_cbranch_scc1 L_noepi
    s_lshl_b32 s60, s34, 9
    s_add_u32 s60, s60, 147456
    v_lshlrev_b32 v39, 8, v1
    v_mov_b32 v37, 1
    s_waitcnt vmcnt(0)
    s_mov_b64 exec, 3
    buffer_atomic_add v37, v39, s[4:7], s60 offen
    s_mov_b64 exec, -1
    s_mov_b32 s74, 0
L_chk_X:
    s_waitcnt lgkmcnt(0)
    s_sub_u32 s68, s68, s32
    s_cmp_eq_u32 s68, 12
    s_cbranch_scc1 L_ok_X
    s_add_u32 s74, s74, 1
    s_cmp_gt_u32 s74, 40000
    s_cbranch_scc1 L_ok_X
    s_mov_b32 s68, 0
    s_atomic_add s68, s[58:59], s67 glc
    s_branch L_chk_X
L_ok_X:
    buffer_load_dwordx4 v[144:147], v47, s[4:7], s63 offen offset:0 sc1
    buffer_load_dwordx4 v[148:151], v47, s[4:7], s63 offen offset:1024 sc1
    s_add_u32 s63, s63, 8192
    buffer_load_dwordx4 v[152:155], v47, s[4:7], s63 offen offset:0 sc1
    buffer_load_dwordx4 v[156:159], v47, s[4:7], s63 offen offset:1024 sc1
    s_add_u32 s63, s63, 8192
    buffer_load_dwordx4 v[160:163], v47, s[4:7], s63 offen offset:0 sc1
    buffer_load_dwordx4 v[164:167], v47, s[4:7], s63 offen offset:1024 sc1
    s_waitcnt vmcnt(4)
    v_lshlrev_b32 v112, 16, v144
    v_and_b32 v113, 0xffff0000, v144
    v_lshlrev_b32 v114, 16, v145
    v_and_b32 v115, 0xffff0000, v145
    v_lshlrev_b32 v116, 16, v146
    v_and_b32 v117, 0xffff0000, v146
    v_lshlrev_b32 v118, 16, v147
    v_and_b32 v119, 0xffff0000, v147
    v_lshlrev_b32 v120, 16, v148
    v_and_b32 v121, 0xffff0000, v148
    v_lshlrev_b32 v122, 16, v149
    v_and_b32 v123, 0xffff0000, v149
    v_lshlrev_b32 v124, 16, v150
    v_and_b32 v125, 0xffff0000, v150
    v_lshlrev_b32 v126, 16, v151
    v_and_b32 v127, 0xffff0000, v151
    v_pk_add_f32 v[64:65], v[64:65], v[112:113]
    v_pk_add_f32 v[66:67], v[66:67], v[114:115]
    v_pk_add_f32 v[68:69], v[68:69], v[116:117]
    v_pk_add_f32 v[70:71], v[70:71], v[118:119]
    v_pk_add_f32 v[72:73], v[72:73], v[120:121]
    v_pk_add_f32 v[74:75], v[74:75], v[122:123]
    v_pk_add_f32 v[76:77], v[76:77], v[124:125]
    v_pk_add_f32 v[78:79], v[78:79], v[126:127]
    s_waitcnt vmcnt(2)
    v_lshlrev_b32 v112, 16, v152
    v_and_b32 v113, 0xffff0000, v152
    v_lshlrev_b32 v114, 16, v153
    v_and_b32 v115, 0xffff0000, v153
    v_lshlrev_b32 v116, 16, v154
    v_and_b32 v117, 0xffff0000, v154
    v_lshlrev_b32 v118, 16, v155
    v_and_b32 v119, 0xffff0000, v155
    v_lshlrev_b32 v120, 16, v156
    v_and_b32 v121, 0xffff0000, v156
    v_lshlrev_b32 v122, 16, v157
    v_and_b32 v123, 0xffff0000, v157
    v_lshlrev_b32 v124, 16, v158
    v_and_b32 v125, 0xffff0000, v158
    v_lshlrev_b32 v126, 16, v159
    v_and_b32 v127, 0xffff0000, v159
    v_pk_add_f32 v[64:65], v[64:65], v[112:113]
    v_pk_add_f32 v[66:67], v[66:67], v[114:115]
    v_pk_add_f32 v[68:69], v[68:69], v[116:117]
    v_pk_add_f32 v[70:71], v[70:71], v[118:119]
    v_pk_add_f32 v[72:73], v[72:73], v[120:121]
    v_pk_add_f32 v[74:75], v[74:75], v[122:123]
    v_pk_add_f32 v[76:77], v[76:77], v[124:125]
    v_pk_add_f32 v[78:79], v[78:79], v[126:127]
    s_waitcnt vmcnt(0)
    v_lshlrev_b32 v112, 16, v160
    v_and_b32 v113, 0xffff0000, v160
    v_lshlrev_b32 v114, 16, v161
    v_and_b32 v115, 0xffff0000, v161
    v_lshlrev_b32 v116, 16, v162
    v_and_b32 v117, 0xffff0000, v162
    v_lshlrev_b32 v118, 16, v163
    v_and_b32 v119, 0xffff0000, v163
    v_lshlrev_b32 v120, 16, v164
    v_and_b32 v121, 0xffff0000, v164
    v_lshlrev_b32 v122, 16, v165
    v_and_b32 v123, 0xffff0000, v165
    v_lshlrev_b32 v124, 16, v166
    v_and_b32 v125, 0xffff0000, v166
    v_lshlrev_b32 v126, 16, v167
    v_and_b32 v127, 0xffff0000, v167
    v_pk_add_f32 v[64:65], v[64:65], v[112:113]
    v_pk_add_f32 v[66:67], v[66:67], v[114:115]
    v_pk_add_f32 v[68:69], v[68:69], v[116:117]
    v_pk_add_f32 v[70:71], v[70:71], v[118:119]
    v_pk_add_f32 v[72:73], v[72:73], v[120:121]
    v_pk_add_f32 v[74:75], v[74:75], v[122:123]
    v_pk_add_f32 v[76:77], v[76:77], v[124:125]
    v_pk_add_f32 v[78:79], v[78:79], v[126:127]
    v_pk_mul_f32 v[128:129], v[64:65], v[64:65]
    v_pk_mul_f32 v[130:131], v[66:67], v[66:67]
    v_pk_mul_f32 v[132:133], v[68:69], v[68:69]
    v_pk_mul_f32 v[134:135], v[70:71], v[70:71]
    v_pk_fma_f32 v[128:129], v[128:129], s[64:65], s[64:65] op_sel:[0,0,1] op_sel_hi:[1,0,1]
    v_pk_fma_f32 v[130:131], v[130:131], s[64:65], s[64:65] op_sel:[0,0,1] op_sel_hi:[1,0,1]
    v_pk_fma_f32 v[132:133], v[132:133], s[64:65], s[64:65] op_sel:[0,0,1] op_sel_hi:[1,0,1]
    v_pk_fma_f32 v[134:135], v[134:135], s[64:65], s[64:65] op_sel:[0,0,1] op_sel_hi:[1,0,1]
    v_pk_mul_f32 v[128:129], v[128:129], v[64:65]
    v_pk_mul_f32 v[130:131], v[130:131], v[66:67]
    v_pk_mul_f32 v[132:133], v[132:133], v[68:69]
    v_pk_mul_f32 v[134:135], v[134:135], v[70:71]
    v_exp_f32 v128, v128
    v_exp_f32 v129, v129
    v_exp_f32 v130, v130
    v_exp_f32 v131, v131
    v_exp_f32 v132, v132
    v_exp_f32 v133, v133
    v_exp_f32 v134, v134
    v_exp_f32 v135, v135
    v_pk_add_f32 v[128:129], v[128:129], 1.0 op_sel_hi:[1,0]
    v_pk_add_f32 v[130:131], v[130:131], 1.0 op_sel_hi:[1,0]
    v_pk_add_f32 v[132:133], v[132:133], 1.0 op_sel_hi:[1,0]
    v_pk_add_f32 v[134:135], v[134:135], 1.0 op_sel_hi:[1,0]
    v_rcp_f32 v128, v128
    v_rcp_f32 v129, v129
    v_rcp_f32 v130, v130
    v_rcp_f32 v131, v131
    v_rcp_f32 v132, v132
    v_rcp_f32 v133, v133
    v_rcp_f32 v134, v134
    v_rcp_f32 v135, v135
    v_pk_mul_f32 v[64:65], v[64:65], v[128:129]
    v_pk_mul_f32 v[66:67], v[66:67], v[130:131]
    v_pk_mul_f32 v[68:69], v[68:69], v[132:133]
    v_pk_mul_f32 v[70:71], v[70:71], v[134:135]
    v_cvt_pk_bf16_f32 v136, v64, v65
    v_cvt_pk_bf16_f32 v137, v66, v67
    v_cvt_pk_bf16_f32 v138, v68, v69
    v_cvt_pk_bf16_f32 v139, v70, v71
    buffer_store_dwordx4 v[136:139], v46, s[4:7], s62 offen offset:0 sc1
    v_pk_mul_f32 v[128:129], v[72:73], v[72:73]
    v_pk_mul_f32 v[130:131], v[74:75], v[74:75]
    v_pk_mul_f32 v[132:133], v[76:77], v[76:77]
    v_pk_mul_f32 v[134:135], v[78:79], v[78:79]
    v_pk_fma_f32 v[128:129], v[128:129], s[64:65], s[64:65] op_sel:[0,0,1] op_sel_hi:[1,0,1]
    v_pk_fma_f32 v[130:131], v[130:131], s[64:65], s[64:65] op_sel:[0,0,1] op_sel_hi:[1,0,1]
    v_pk_fma_f32 v[132:133], v[132:133], s[64:65], s[64:65] op_sel:[0,0,1] op_sel_hi:[1,0,1]
    v_pk_fma_f32 v[134:135], v[134:135], s[64:65], s[64:65] op_sel:[0,0,1] op_sel_hi:[1,0,1]
    v_pk_mul_f32 v[128:129], v[128:129], v[72:73]
    v_pk_mul_f32 v[130:131], v[130:131], v[74:75]
    v_pk_mul_f32 v[132:133], v[132:133], v[76:77]
    v_pk_mul_f32 v[134:135], v[134:135], v[78:79]
    v_exp_f32 v128, v128
    v_exp_f32 v129, v129
    v_exp_f32 v130, v130
    v_exp_f32 v131, v131
    v_exp_f32 v132, v132
    v_exp_f32 v133, v133
    v_exp_f32 v134, v134
    v_exp_f32 v135, v135
    v_pk_add_f32 v[128:129], v[128:129], 1.0 op_sel_hi:[1,0]
    v_pk_add_f32 v[130:131], v[130:131], 1.0 op_sel_hi:[1,0]
    v_pk_add_f32 v[132:133], v[132:133], 1.0 op_sel_hi:[1,0]
    v_pk_add_f32 v[134:135], v[134:135], 1.0 op_sel_hi:[1,0]
    v_rcp_f32 v128, v128
    v_rcp_f32 v129, v129
    v_rcp_f32 v130, v130
    v_rcp_f32 v131, v131
    v_rcp_f32 v132, v132
    v_rcp_f32 v133, v133
    v_rcp_f32 v134, v134
    v_rcp_f32 v135, v135
    v_pk_mul_f32 v[72:73], v[72:73], v[128:129]
    v_pk_mul_f32 v[74:75], v[74:75], v[130:131]
    v_pk_mul_f32 v[76:77], v[76:77], v[132:133]
    v_pk_mul_f32 v[78:79], v[78:79], v[134:135]
    v_cvt_pk_bf16_f32 v140, v72, v73
    v_cvt_pk_bf16_f32 v141, v74, v75
    v_cvt_pk_bf16_f32 v142, v76, v77
    v_cvt_pk_bf16_f32 v143, v78, v79
    buffer_store_dwordx4 v[140:143], v46, s[4:7], s62 offen offset:2048 sc1
    s_lshl_b32 s60, s88, 13
    s_lshl_b32 s61, s3, 8
    s_add_u32 s60, s60, s61
    s_add_u32 s60, s60, 262144
    v_lshlrev_b32 v39, 10, v1
    v_mov_b32 v37, 1
    s_waitcnt vmcnt(0)
    s_mov_b64 exec, 255
    buffer_atomic_add v37, v39, s[4:7], s60 offen
    s_mov_b64 exec, -1
L_noepi:
    v_lshlrev_b32 v64, 16, v249
    v_lshlrev_b32 v65, 16, v249
    v_mov_b64 v[66:67], v[64:65]
    v_mov_b64 v[68:69], v[64:65]
    v_mov_b64 v[70:71], v[64:65]
    v_mov_b64 v[72:73], v[64:65]
    v_mov_b64 v[74:75], v[64:65]
    v_mov_b64 v[76:77], v[64:65]
    v_mov_b64 v[78:79], v[64:65]
    s_barrier
    ds_read_b64_tr_b16 v[112:113], v5 offset:49152
    ds_read_b64_tr_b16 v[114:115], v5 offset:50176
    ds_read_b128 v[116:119], v7 offset:49152
    ds_read_b64_tr_b16 v[120:121], v5 offset:51200
    ds_read_b64_tr_b16 v[122:123], v5 offset:52224
    ds_read_b128 v[124:127], v7 offset:51200
    ds_read_b64_tr_b16 v[128:129], v5 offset:53248
    ds_read_b64_tr_b16 v[130:131], v5 offset:54272
    ds_read_b128 v[132:135], v7 offset:53248
    ds_read_b64_tr_b16 v[136:137], v5 offset:55296
    ds_read_b64_tr_b16 v[138:139], v5 offset:56320
    ds_read_b128 v[140:143], v7 offset:55296
    s_barrier
    s_waitcnt lgkmcnt(9)
    v_mfma_f32_32x32x16_bf16 v[48:63], v[112:115], v[116:119], 0
    ds_read_b64_tr_b16 v[144:145], v5 offset:57344
    ds_read_b64_tr_b16 v[146:147], v5 offset:58368
    ds_read_b128 v[148:151], v7 offset:57344
    s_waitcnt lgkmcnt(9)
    v_mfma_f32_32x32x16_bf16 v[48:63], v[120:123], v[124:127], v[48:63]
    ds_read_b64_tr_b16 v[152:153], v5 offset:59392
    ds_read_b64_tr_b16 v[154:155], v5 offset:60416
    ds_read_b128 v[156:159], v7 offset:59392
    s_waitcnt lgkmcnt(9)
    v_mfma_f32_32x32x16_bf16 v[48:63], v[128:131], v[132:135], v[48:63]
    ds_read_b64_tr_b16 v[160:161], v5 offset:61440
    ds_read_b64_tr_b16 v[162:163], v5 offset:62464
    ds_read_b128 v[164:167], v7 offset:61440
    s_waitcnt lgkmcnt(9)
    v_mfma_f32_32x32x16_bf16 v[48:63], v[136:139], v[140:143], v[48:63]
    ds_read_b64_tr_b16 v[168:169], v5 offset:63488
    ds_read_b64_tr_b16 v[170:171], v5 offset:64512
    ds_read_b128 v[172:175], v7 offset:63488
    s_barrier
    s_waitcnt lgkmcnt(9)
    v_mfma_f32_32x32x16_bf16 v[48:63], v[144:147], v[148:151], v[48:63]
    ds_read_b64_tr_b16 v[112:113], v6 offset:0
    ds_read_b64_tr_b16 v[114:115], v6 offset:1024
    ds_read_b128 v[116:119], v8 offset:0
    s_waitcnt lgkmcnt(9)
    v_mfma_f32_32x32x16_bf16 v[48:63], v[152:155], v[156:159], v[48:63]
    ds_read_b64_tr_b16 v[120:121], v6 offset:2048
    ds_read_b64_tr_b16 v[122:123], v6 offset:3072
    ds_read_b128 v[124:127], v8 offset:2048
    s_waitcnt lgkmcnt(9)
    v_mfma_f32_32x32x16_bf16 v[48:63], v[160:163], v[164:167], v[48:63]
    ds_read_b64_tr_b16 v[128:129], v6 offset:4096
    ds_read_b64_tr_b16 v[130:131], v6 offset:5120
    ds_read_b128 v[132:135], v8 offset:4096
    s_waitcnt lgkmcnt(9)
    v_mfma_f32_32x32x16_bf16 v[48:63], v[168:171], v[172:175], v[48:63]
    ds_read_b64_tr_b16 v[136:137], v6 offset:6144
    ds_read_b64_tr_b16 v[138:139], v6 offset:7168
    ds_read_b128 v[140:143], v8 offset:6144
    s_barrier
    s_waitcnt lgkmcnt(9)
    v_mfma_f32_32x32x16_bf16 v[48:63], v[112:115], v[116:119], v[48:63]
    ds_read_b64_tr_b16 v[144:145], v6 offset:8192
    ds_read_b64_tr_b16 v[146:147], v6 offset:9216
    ds_read_b128 v[148:151], v8 offset:8192
    s_waitcnt lgkmcnt(9)
    v_mfma_f32_32x32x16_bf16 v[48:63], v[120:123], v[124:127], v[48:63]
    ds_read_b64_tr_b16 v[152:153], v6 offset:10240
    ds_read_b64_tr_b16 v[154:155], v6 offset:11264
    ds_read_b128 v[156:159], v8 offset:10240
    s_waitcnt lgkmcnt(9)
    v_mfma_f32_32x32x16_bf16 v[48:63], v[128:131], v[132:135], v[48:63]
    ds_read_b64_tr_b16 v[160:161], v6 offset:12288
    ds_read_b64_tr_b16 v[162:163], v6 offset:13312
    ds_read_b128 v[164:167], v8 offset:12288
    s_waitcnt lgkmcnt(9)
    v_mfma_f32_32x32x16_bf16 v[48:63], v[136:139], v[140:143], v[48:63]
    ds_read_b64_tr_b16 v[168:169], v6 offset:14336
    ds_read_b64_tr_b16 v[170:171], v6 offset:15360
    ds_read_b128 v[172:175], v8 offset:14336
    s_barrier
    s_waitcnt lgkmcnt(9)
    v_mfma_f32_32x32x16_bf16 v[48:63], v[144:147], v[148:151], v[48:63]
    ds_read_b64_tr_b16 v[112:113], v6 offset:16384
    ds_read_b64_tr_b16 v[114:115], v6 offset:17408
    ds_read_b128 v[116:119], v8 offset:16384
    s_waitcnt lgkmcnt(9)
    v_mfma_f32_32x32x16_bf16 v[48:63], v[152:155], v[156:159], v[48:63]
    ds_read_b64_tr_b16 v[120:121], v6 offset:18432
    ds_read_b64_tr_b16 v[122:123], v6 offset:19456
    ds_read_b128 v[124:127], v8 offset:18432
    s_waitcnt lgkmcnt(9)
    v_mfma_f32_32x32x16_bf16 v[48:63], v[160:163], v[164:167], v[48:63]
    ds_read_b64_tr_b16 v[128:129], v6 offset:20480
    ds_read_b64_tr_b16 v[130:131], v6 offset:21504
    ds_read_b128 v[132:135], v8 offset:20480
    s_waitcnt lgkmcnt(9)
    v_mfma_f32_32x32x16_bf16 v[48:63], v[168:171], v[172:175], v[48:63]
    ds_read_b64_tr_b16 v[136:137], v6 offset:22528
    ds_read_b64_tr_b16 v[138:139], v6 offset:23552
    ds_read_b128 v[140:143], v8 offset:22528
    s_barrier
    s_waitcnt lgkmcnt(9)
    v_mfma_f32_32x32x16_bf16 v[48:63], v[112:115], v[116:119], v[48:63]
    ds_read_b64_tr_b16 v[144:145], v4 offset:0
    ds_read_b64_tr_b16 v[146:147], v4 offset:1024
    ds_read_b128 v[148:151], v8 offset:24576
    s_waitcnt lgkmcnt(9)
    v_mfma_f32_32x32x16_bf16 v[48:63], v[120:123], v[124:127], v[48:63]
    ds_read_b64_tr_b16 v[152:153], v4 offset:2048
    ds_read_b64_tr_b16 v[154:155], v4 offset:3072
    ds_read_b128 v[156:159], v8 offset:26624
    s_waitcnt lgkmcnt(9)
    v_mfma_f32_32x32x16_bf16 v[48:63], v[128:131], v[132:135], v[48:63]
    ds_read_b64_tr_b16 v[160:161], v4 offset:4096
    ds_read_b64_tr_b16 v[162:163], v4 offset:5120
    ds_read_b128 v[164:167], v8 offset:28672
    s_waitcnt lgkmcnt(9)
    v_mfma_f32_32x32x16_bf16 v[48:63], v[136:139], v[140:143], v[48:63]
    ds_read_b64_tr_b16 v[168:169], v4 offset:6144
    ds_read_b64_tr_b16 v[170:171], v4 offset:7168
    ds_read_b128 v[172:175], v8 offset:30720
    s_barrier
    s_waitcnt lgkmcnt(9)
    v_mfma_f32_32x32x16_bf16 v[48:63], v[144:147], v[148:151], v[48:63]
    ds_read_b64_tr_b16 v[112:113], v4 offset:8192
    ds_read_b64_tr_b16 v[114:115], v4 offset:9216
    ds_read_b128 v[116:119], v8 offset:32768
    s_waitcnt lgkmcnt(9)
    v_mfma_f32_32x32x16_bf16 v[48:63], v[152:155], v[156:159], v[48:63]
    ds_read_b64_tr_b16 v[120:121], v4 offset:10240
    ds_read_b64_tr_b16 v[122:123], v4 offset:11264
    ds_read_b128 v[124:127], v8 offset:34816
    s_waitcnt lgkmcnt(9)
    v_mfma_f32_32x32x16_bf16 v[48:63], v[160:163], v[164:167], v[48:63]
    ds_read_b64_tr_b16 v[128:129], v4 offset:12288
    ds_read_b64_tr_b16 v[130:131], v4 offset:13312
    ds_read_b128 v[132:135], v8 offset:36864
    s_waitcnt lgkmcnt(9)
    v_mfma_f32_32x32x16_bf16 v[48:63], v[168:171], v[172:175], v[48:63]
    ds_read_b64_tr_b16 v[136:137], v4 offset:14336
    ds_read_b64_tr_b16 v[138:139], v4 offset:15360
    ds_read_b128 v[140:143], v8 offset:38912
    s_barrier
    s_waitcnt lgkmcnt(9)
    v_mfma_f32_32x32x16_bf16 v[48:63], v[112:115], v[116:119], v[48:63]
    ds_read_b64_tr_b16 v[144:145], v4 offset:16384
    ds_read_b64_tr_b16 v[146:147], v4 offset:17408
    ds_read_b128 v[148:151], v8 offset:40960
    s_waitcnt lgkmcnt(9)
    v_mfma_f32_32x32x16_bf16 v[48:63], v[120:123], v[124:127], v[48:63]
    ds_read_b64_tr_b16 v[152:153], v4 offset:18432
    ds_read_b64_tr_b16 v[154:155], v4 offset:19456
    ds_read_b128 v[156:159], v8 offset:43008
    s_waitcnt lgkmcnt(9)
    v_mfma_f32_32x32x16_bf16 v[48:63], v[128:131], v[132:135], v[48:63]
    ds_read_b64_tr_b16 v[160:161], v4 offset:20480
    ds_read_b64_tr_b16 v[162:163], v4 offset:21504
    ds_read_b128 v[164:167], v8 offset:45056
    s_waitcnt lgkmcnt(9)
    v_mfma_f32_32x32x16_bf16 v[48:63], v[136:139], v[140:143], v[48:63]
    ds_read_b64_tr_b16 v[168:169], v4 offset:22528
    ds_read_b64_tr_b16 v[170:171], v4 offset:23552
    ds_read_b128 v[172:175], v8 offset:47104
    s_mov_b32 s64, 0xbfb8aa3b
    v_lshlrev_b32 v40, 4, v43
    v_lshl_add_u32 v40, v2, 10, v40
    v_and_b32 v41, 1, v3
    v_lshl_add_u32 v40, v41, 5, v40
    v_add_u32 v41, 16384, v40
    s_lshl_b32 s62, s34, 16
    s_lshl_b32 s61, s72, 15
    s_add_u32 s62, s62, s61
    s_lshl_b32 s61, s35, 7
    s_add_u32 s62, s62, s61
    s_lshl_b32 s61, s71, 6
    s_add_u32 s62, s62, s61
    s_barrier
    s_waitcnt lgkmcnt(9)
    v_mfma_f32_32x32x16_bf16 v[48:63], v[144:147], v[148:151], v[48:63]
    ds_read_b128 v[112:115], v14 offset:16384
    s_waitcnt lgkmcnt(7)
    v_mfma_f32_32x32x16_bf16 v[48:63], v[152:155], v[156:159], v[48:63]
    ds_read_b128 v[120:123], v14 offset:18432
    s_waitcnt lgkmcnt(5)
    v_mfma_f32_32x32x16_bf16 v[48:63], v[160:163], v[164:167], v[48:63]
    s_waitcnt lgkmcnt(2)
    v_mfma_f32_32x32x16_bf16 v[48:63], v[168:171], v[172:175], v[48:63]
    s_barrier
    s_waitcnt lgkmcnt(1)
    v_mfma_f32_32x32x16_bf16 v[64:79], v[112:115], v[80:83], v[64:79]
    ds_read_b128 v[144:147], v13 offset:0
    s_waitcnt lgkmcnt(1)
    v_mfma_f32_32x32x16_bf16 v[64:79], v[120:123], v[84:87], v[64:79]
    ds_read_b128 v[152:155], v13 offset:2048
    ds_read_b128 v[160:163], v13 offset:4096
    ds_read_b128 v[168:171], v13 offset:6144
    s_barrier
    s_waitcnt lgkmcnt(3)
    v_mfma_f32_32x32x16_bf16 v[64:79], v[144:147], v[88:91], v[64:79]
    ds_read_b128 v[112:115], v14 offset:24576
    s_waitcnt lgkmcnt(3)
    v_mfma_f32_32x32x16_bf16 v[64:79], v[152:155], v[92:95], v[64:79]
    ds_read_b128 v[120:123], v14 offset:26624
    s_waitcnt lgkmcnt(3)
    v_mfma_f32_32x32x16_bf16 v[64:79], v[160:163], v[96:99], v[64:79]
    ds_read_b128 v[128:131], v14 offset:28672
    s_waitcnt lgkmcnt(3)
    v_mfma_f32_32x32x16_bf16 v[64:79], v[168:171], v[100:103], v[64:79]
    ds_read_b128 v[136:139], v14 offset:30720
    s_barrier
    s_waitcnt lgkmcnt(3)
    v_mfma_f32_32x32x16_bf16 v[64:79], v[112:115], v[104:107], v[64:79]
    ds_read_b128 v[144:147], v13 offset:8192
    s_waitcnt lgkmcnt(3)
    v_mfma_f32_32x32x16_bf16 v[64:79], v[120:123], v[108:111], v[64:79]
    ds_read_b128 v[152:155], v13 offset:10240
    s_waitcnt lgkmcnt(3)
    v_mfma_f32_32x32x16_bf16 v[64:79], v[128:131], v[176:179], v[64:79]
    ds_read_b128 v[160:163], v13 offset:12288
    s_waitcnt lgkmcnt(3)
    v_mfma_f32_32x32x16_bf16 v[64:79], v[136:139], v[180:183], v[64:79]
    ds_read_b128 v[168:171], v13 offset:14336
    v_lshlrev_b32 v80, 16, v20
    v_and_b32 v81, 0xffff0000, v20
    v_lshlrev_b32 v82, 16, v21
    v_and_b32 v83, 0xffff0000, v21
    s_barrier
    s_waitcnt lgkmcnt(3)
    v_mfma_f32_32x32x16_bf16 v[64:79], v[144:147], v[184:187], v[64:79]
    ds_read_b128 v[112:115], v14 offset:32768
    s_waitcnt lgkmcnt(3)
    v_mfma_f32_32x32x16_bf16 v[64:79], v[152:155], v[188:191], v[64:79]
    ds_read_b128 v[120:123], v14 offset:34816
    s_waitcnt lgkmcnt(3)
    v_mfma_f32_32x32x16_bf16 v[64:79], v[160:163], v[192:195], v[64:79]
    ds_read_b128 v[128:131], v14 offset:36864
    s_waitcnt lgkmcnt(3)
    v_mfma_f32_32x32x16_bf16 v[64:79], v[168:171], v[196:199], v[64:79]
    ds_read_b128 v[136:139], v14 offset:38912
    v_lshlrev_b32 v84, 16, v22
    v_and_b32 v85, 0xffff0000, v22
    v_lshlrev_b32 v86, 16, v23
    v_and_b32 v87, 0xffff0000, v23
    s_barrier
    s_waitcnt lgkmcnt(3)
    v_mfma_f32_32x32x16_bf16 v[64:79], v[112:115], v[200:203], v[64:79]
    ds_read_b128 v[144:147], v13 offset:16384
    s_waitcnt lgkmcnt(3)
    v_mfma_f32_32x32x16_bf16 v[64:79], v[120:123], v[204:207], v[64:79]
    ds_read_b128 v[152:155], v13 offset:18432
    s_waitcnt lgkmcnt(3)
    v_mfma_f32_32x32x16_bf16 v[64:79], v[128:131], v[208:211], v[64:79]
    ds_read_b128 v[160:163], v13 offset:20480
    s_waitcnt lgkmcnt(3)
    v_mfma_f32_32x32x16_bf16 v[64:79], v[136:139], v[212:215], v[64:79]
    ds_read_b128 v[168:171], v13 offset:22528
    v_lshlrev_b32 v88, 16, v24
    v_and_b32 v89, 0xffff0000, v24
    v_lshlrev_b32 v90, 16, v25
    v_and_b32 v91, 0xffff0000, v25
    s_barrier
    s_waitcnt lgkmcnt(3)
    v_mfma_f32_32x32x16_bf16 v[64:79], v[144:147], v[216:219], v[64:79]
    ds_read_b128 v[112:115], v14 offset:40960
    s_waitcnt lgkmcnt(3)
    v_mfma_f32_32x32x16_bf16 v[64:79], v[152:155], v[220:223], v[64:79]
    ds_read_b128 v[120:123], v14 offset:43008
    s_waitcnt lgkmcnt(3)
    v_mfma_f32_32x32x16_bf16 v[64:79], v[160:163], v[224:227], v[64:79]
    ds_read_b128 v[128:131], v14 offset:45056
    s_waitcnt lgkmcnt(3)
    v_mfma_f32_32x32x16_bf16 v[64:79], v[168:171], v[228:231], v[64:79]
    ds_read_b128 v[136:139], v14 offset:47104
    v_lshlrev_b32 v92, 16, v26
    v_and_b32 v93, 0xffff0000, v26
    v_lshlrev_b32 v94, 16, v27
    v_and_b32 v95, 0xffff0000, v27
    s_barrier
    s_waitcnt lgkmcnt(3)
    v_mfma_f32_32x32x16_bf16 v[64:79], v[112:115], v[232:235], v[64:79]
    ds_read_b128 v[144:147], v14 offset:16384
    ds_read_b64_tr_b16 v[148:149], v10 offset:24576
    ds_read_b64_tr_b16 v[150:151], v10 offset:25600
    s_waitcnt lgkmcnt(5)
    v_mfma_f32_32x32x16_bf16 v[64:79], v[120:123], v[236:239], v[64:79]
    ds_read_b128 v[152:155], v14 offset:18432
    ds_read_b64_tr_b16 v[156:157], v10 offset:26624
    ds_read_b64_tr_b16 v[158:159], v10 offset:27648
    s_waitcnt lgkmcnt(7)
    v_mfma_f32_32x32x16_bf16 v[64:79], v[128:131], v[240:243], v[64:79]
    ds_read_b128 v[160:163], v14 offset:20480
    ds_read_b64_tr_b16 v[164:165], v10 offset:28672
    ds_read_b64_tr_b16 v[166:167], v10 offset:29696
    s_waitcnt lgkmcnt(9)
    v_mfma_f32_32x32x16_bf16 v[64:79], v[136:139], v[244:247], v[64:79]
    ds_read_b128 v[168:171], v14 offset:22528
    ds_read_b64_tr_b16 v[172:173], v10 offset:30720
    ds_read_b64_tr_b16 v[174:175], v10 offset:31744
    s_barrier
    s_waitcnt lgkmcnt(9)
    v_mfma_f32_32x32x16_bf16 v[64:79], v[144:147], v[148:151], v[64:79]
    ds_read_b128 v[112:115], v13 offset:0
    ds_read_b64_tr_b16 v[116:117], v10 offset:32768
    ds_read_b64_tr_b16 v[118:119], v10 offset:33792
    s_waitcnt lgkmcnt(9)
    v_mfma_f32_32x32x16_bf16 v[64:79], v[152:155], v[156:159], v[64:79]
    ds_read_b128 v[120:123], v13 offset:2048
    ds_read_b64_tr_b16 v[124:125], v10 offset:34816
    ds_read_b64_tr_b16 v[126:127], v10 offset:35840
    s_waitcnt lgkmcnt(9)
    v_mfma_f32_32x32x16_bf16 v[64:79], v[160:163], v[164:167], v[64:79]
    ds_read_b128 v[128:131], v13 offset:4096
    ds_read_b64_tr_b16 v[132:133], v10 offset:36864
    ds_read_b64_tr_b16 v[134:135], v10 offset:37888
    s_waitcnt lgkmcnt(9)
    v_mfma_f32_32x32x16_bf16 v[64:79], v[168:171], v[172:175], v[64:79]
    ds_read_b128 v[136:139], v13 offset:6144
    ds_read_b64_tr_b16 v[140:141], v10 offset:38912
    ds_read_b64_tr_b16 v[142:143], v10 offset:39936
    s_barrier
    s_waitcnt lgkmcnt(9)
    v_mfma_f32_32x32x16_bf16 v[64:79], v[112:115], v[116:119], v[64:79]
    ds_read_b128 v[144:147], v14 offset:24576
    ds_read_b64_tr_b16 v[148:149], v10 offset:40960
    ds_read_b64_tr_b16 v[150:151], v10 offset:41984
    s_waitcnt lgkmcnt(9)
    v_mfma_f32_32x32x16_bf16 v[64:79], v[120:123], v[124:127], v[64:79]
    ds_read_b128 v[152:155], v14 offset:26624
    ds_read_b64_tr_b16 v[156:157], v10 offset:43008
    ds_read_b64_tr_b16 v[158:159], v10 offset:44032
    s_waitcnt lgkmcnt(9)
    v_mfma_f32_32x32x16_bf16 v[64:79], v[128:131], v[132:135], v[64:79]
    ds_read_b128 v[160:163], v14 offset:28672
    ds_read_b64_tr_b16 v[164:165], v10 offset:45056
    ds_read_b64_tr_b16 v[166:167], v10 offset:46080
    s_waitcnt lgkmcnt(9)
    v_mfma_f32_32x32x16_bf16 v[64:79], v[136:139], v[140:143], v[64:79]
    ds_read_b128 v[168:171], v14 offset:30720
    ds_read_b64_tr_b16 v[172:173], v10 offset:47104
    ds_read_b64_tr_b16 v[174:175], v10 offset:48128
    s_barrier
    s_waitcnt lgkmcnt(9)
    v_mfma_f32_32x32x16_bf16 v[64:79], v[144:147], v[148:151], v[64:79]
    ds_read_b128 v[112:115], v13 offset:8192
    ds_read_b64_tr_b16 v[116:117], v11 offset:49152
    ds_read_b64_tr_b16 v[118:119], v11 offset:50176
    s_waitcnt lgkmcnt(9)
    v_mfma_f32_32x32x16_bf16 v[64:79], v[152:155], v[156:159], v[64:79]
    ds_read_b128 v[120:123], v13 offset:10240
    ds_read_b64_tr_b16 v[124:125], v11 offset:51200
    ds_read_b64_tr_b16 v[126:127], v11 offset:52224
    s_waitcnt lgkmcnt(9)
    v_mfma_f32_32x32x16_bf16 v[64:79], v[160:163], v[164:167], v[64:79]
    ds_read_b128 v[128:131], v13 offset:12288
    ds_read_b64_tr_b16 v[132:133], v11 offset:53248
    ds_read_b64_tr_b16 v[134:135], v11 offset:54272
    s_waitcnt lgkmcnt(9)
    v_mfma_f32_32x32x16_bf16 v[64:79], v[168:171], v[172:175], v[64:79]
    ds_read_b128 v[136:139], v13 offset:14336
    ds_read_b64_tr_b16 v[140:141], v11 offset:55296
    ds_read_b64_tr_b16 v[142:143], v11 offset:56320
    s_barrier
    s_waitcnt lgkmcnt(9)
    v_mfma_f32_32x32x16_bf16 v[64:79], v[112:115], v[116:119], v[64:79]
    ds_read_b128 v[144:147], v14 offset:32768
    ds_read_b64_tr_b16 v[148:149], v10 offset:49152
    ds_read_b64_tr_b16 v[150:151], v10 offset:50176
    s_waitcnt lgkmcnt(9)
    v_mfma_f32_32x32x16_bf16 v[64:79], v[120:123], v[124:127], v[64:79]
    ds_read_b128 v[152:155], v14 offset:34816
    ds_read_b64_tr_b16 v[156:157], v10 offset:51200
    ds_read_b64_tr_b16 v[158:159], v10 offset:52224
    s_waitcnt lgkmcnt(9)
    v_mfma_f32_32x32x16_bf16 v[64:79], v[128:131], v[132:135], v[64:79]
    ds_read_b128 v[160:163], v14 offset:36864
    ds_read_b64_tr_b16 v[164:165], v10 offset:53248
    ds_read_b64_tr_b16 v[166:167], v10 offset:54272
    s_waitcnt lgkmcnt(9)
    v_mfma_f32_32x32x16_bf16 v[64:79], v[136:139], v[140:143], v[64:79]
    ds_read_b128 v[168:171], v14 offset:38912
    ds_read_b64_tr_b16 v[172:173], v10 offset:55296
    ds_read_b64_tr_b16 v[174:175], v10 offset:56320
    s_barrier
    s_waitcnt lgkmcnt(9)
    v_mfma_f32_32x32x16_bf16 v[64:79], v[144:147], v[148:151], v[64:79]
    ds_read_b128 v[112:115], v13 offset:16384
    ds_read_b64_tr_b16 v[116:117], v11 offset:57344
    ds_read_b64_tr_b16 v[118:119], v11 offset:58368
    s_waitcnt lgkmcnt(9)
    v_mfma_f32_32x32x16_bf16 v[64:79], v[152:155], v[156:159], v[64:79]
    ds_read_b128 v[120:123], v13 offset:18432
    ds_read_b64_tr_b16 v[124:125], v11 offset:59392
    ds_read_b64_tr_b16 v[126:127], v11 offset:60416
    s_waitcnt lgkmcnt(9)
    v_mfma_f32_32x32x16_bf16 v[64:79], v[160:163], v[164:167], v[64:79]
    ds_read_b128 v[128:131], v13 offset:20480
    ds_read_b64_tr_b16 v[132:133], v11 offset:61440
    ds_read_b64_tr_b16 v[134:135], v11 offset:62464
    s_waitcnt lgkmcnt(9)
    v_mfma_f32_32x32x16_bf16 v[64:79], v[168:171], v[172:175], v[64:79]
    ds_read_b128 v[136:139], v13 offset:22528
    ds_read_b64_tr_b16 v[140:141], v11 offset:63488
    ds_read_b64_tr_b16 v[142:143], v11 offset:64512
    s_barrier
    s_waitcnt lgkmcnt(9)
    v_mfma_f32_32x32x16_bf16 v[64:79], v[112:115], v[116:119], v[64:79]
    ds_read_b128 v[144:147], v14 offset:40960
    ds_read_b64_tr_b16 v[148:149], v10 offset:57344
    ds_read_b64_tr_b16 v[150:151], v10 offset:58368
    s_waitcnt lgkmcnt(9)
    v_mfma_f32_32x32x16_bf16 v[64:79], v[120:123], v[124:127], v[64:79]
    ds_read_b128 v[152:155], v14 offset:43008
    ds_read_b64_tr_b16 v[156:157], v10 offset:59392
    ds_read_b64_tr_b16 v[158:159], v10 offset:60416
    s_waitcnt lgkmcnt(9)
    v_mfma_f32_32x32x16_bf16 v[64:79], v[128:131], v[132:135], v[64:79]
    ds_read_b128 v[160:163], v14 offset:45056
    ds_read_b64_tr_b16 v[164:165], v10 offset:61440
    ds_read_b64_tr_b16 v[166:167], v10 offset:62464
    s_waitcnt lgkmcnt(9)
    v_mfma_f32_32x32x16_bf16 v[64:79], v[136:139], v[140:143], v[64:79]
    ds_read_b128 v[168:171], v14 offset:47104
    ds_read_b64_tr_b16 v[172:173], v10 offset:63488
    ds_read_b64_tr_b16 v[174:175], v10 offset:64512
    s_barrier
    s_waitcnt lgkmcnt(9)
    v_mfma_f32_32x32x16_bf16 v[64:79], v[144:147], v[148:151], v[64:79]
    ds_read_b128 v[112:115], v13 offset:24576
    ds_read_b64_tr_b16 v[116:117], v12 offset:0
    ds_read_b64_tr_b16 v[118:119], v12 offset:1024
    s_waitcnt lgkmcnt(9)
    v_mfma_f32_32x32x16_bf16 v[64:79], v[152:155], v[156:159], v[64:79]
    ds_read_b128 v[120:123], v13 offset:26624
    ds_read_b64_tr_b16 v[124:125], v12 offset:2048
    ds_read_b64_tr_b16 v[126:127], v12 offset:3072
    s_waitcnt lgkmcnt(9)
    v_mfma_f32_32x32x16_bf16 v[64:79], v[160:163], v[164:167], v[64:79]
    ds_read_b128 v[128:131], v13 offset:28672
    ds_read_b64_tr_b16 v[132:133], v12 offset:4096
    ds_read_b64_tr_b16 v[134:135], v12 offset:5120
    s_waitcnt lgkmcnt(9)
    v_mfma_f32_32x32x16_bf16 v[64:79], v[168:171], v[172:175], v[64:79]
    ds_read_b128 v[136:139], v13 offset:30720
    ds_read_b64_tr_b16 v[140:141], v12 offset:6144
    ds_read_b64_tr_b16 v[142:143], v12 offset:7168
    s_barrier
    s_waitcnt lgkmcnt(9)
    v_mfma_f32_32x32x16_bf16 v[64:79], v[112:115], v[116:119], v[64:79]
    ds_read_b128 v[144:147], v14 offset:16384
    ds_read_b64_tr_b16 v[148:149], v11 offset:0
    ds_read_b64_tr_b16 v[150:151], v11 offset:1024
    s_waitcnt lgkmcnt(9)
    v_mfma_f32_32x32x16_bf16 v[64:79], v[120:123], v[124:127], v[64:79]
    ds_read_b128 v[152:155], v14 offset:18432
    ds_read_b64_tr_b16 v[156:157], v11 offset:2048
    ds_read_b64_tr_b16 v[158:159], v11 offset:3072
    s_waitcnt lgkmcnt(9)
    v_mfma_f32_32x32x16_bf16 v[64:79], v[128:131], v[132:135], v[64:79]
    ds_read_b128 v[160:163], v14 offset:20480
    ds_read_b64_tr_b16 v[164:165], v11 offset:4096
    ds_read_b64_tr_b16 v[166:167], v11 offset:5120
    s_waitcnt lgkmcnt(9)
    v_mfma_f32_32x32x16_bf16 v[64:79], v[136:139], v[140:143], v[64:79]
    ds_read_b128 v[168:171], v14 offset:22528
    ds_read_b64_tr_b16 v[172:173], v11 offset:6144
    ds_read_b64_tr_b16 v[174:175], v11 offset:7168
    s_barrier
    s_waitcnt lgkmcnt(9)
    v_mfma_f32_32x32x16_bf16 v[64:79], v[144:147], v[148:151], v[64:79]
    ds_read_b128 v[112:115], v13 offset:32768
    ds_read_b64_tr_b16 v[116:117], v12 offset:8192
    ds_read_b64_tr_b16 v[118:119], v12 offset:9216
    s_waitcnt lgkmcnt(9)
    v_mfma_f32_32x32x16_bf16 v[64:79], v[152:155], v[156:159], v[64:79]
    ds_read_b128 v[120:123], v13 offset:34816
    ds_read_b64_tr_b16 v[124:125], v12 offset:10240
    ds_read_b64_tr_b16 v[126:127], v12 offset:11264
    s_waitcnt lgkmcnt(9)
    v_mfma_f32_32x32x16_bf16 v[64:79], v[160:163], v[164:167], v[64:79]
    ds_read_b128 v[128:131], v13 offset:36864
    ds_read_b64_tr_b16 v[132:133], v12 offset:12288
    ds_read_b64_tr_b16 v[134:135], v12 offset:13312
    s_waitcnt lgkmcnt(9)
    v_mfma_f32_32x32x16_bf16 v[64:79], v[168:171], v[172:175], v[64:79]
    ds_read_b128 v[136:139], v13 offset:38912
    ds_read_b64_tr_b16 v[140:141], v12 offset:14336
    ds_read_b64_tr_b16 v[142:143], v12 offset:15360
    s_barrier
    s_waitcnt lgkmcnt(9)
    v_mfma_f32_32x32x16_bf16 v[64:79], v[112:115], v[116:119], v[64:79]
    ds_read_b128 v[144:147], v13 offset:0
    ds_read_b64_tr_b16 v[148:149], v11 offset:8192
    ds_read_b64_tr_b16 v[150:151], v11 offset:9216
    s_waitcnt lgkmcnt(9)
    v_mfma_f32_32x32x16_bf16 v[64:79], v[120:123], v[124:127], v[64:79]
    ds_read_b128 v[152:155], v13 offset:2048
    ds_read_b64_tr_b16 v[156:157], v11 offset:10240
    ds_read_b64_tr_b16 v[158:159], v11 offset:11264
    s_waitcnt lgkmcnt(9)
    v_mfma_f32_32x32x16_bf16 v[64:79], v[128:131], v[132:135], v[64:79]
    ds_read_b128 v[160:163], v13 offset:4096
    ds_read_b64_tr_b16 v[164:165], v11 offset:12288
    ds_read_b64_tr_b16 v[166:167], v11 offset:13312
    s_waitcnt lgkmcnt(9)
    v_mfma_f32_32x32x16_bf16 v[64:79], v[136:139], v[140:143], v[64:79]
    ds_read_b128 v[168:171], v13 offset:6144
    ds_read_b64_tr_b16 v[172:173], v11 offset:14336
    ds_read_b64_tr_b16 v[174:175], v11 offset:15360
    s_barrier
    s_waitcnt lgkmcnt(9)
    v_mfma_f32_32x32x16_bf16 v[64:79], v[144:147], v[148:151], v[64:79]
    ds_read_b128 v[112:115], v13 offset:40960
    ds_read_b64_tr_b16 v[116:117], v12 offset:16384
    ds_read_b64_tr_b16 v[118:119], v12 offset:17408
    s_waitcnt lgkmcnt(9)
    v_mfma_f32_32x32x16_bf16 v[64:79], v[152:155], v[156:159], v[64:79]
    ds_read_b128 v[120:123], v13 offset:43008
    ds_read_b64_tr_b16 v[124:125], v12 offset:18432
    ds_read_b64_tr_b16 v[126:127], v12 offset:19456
    s_waitcnt lgkmcnt(9)
    v_mfma_f32_32x32x16_bf16 v[64:79], v[160:163], v[164:167], v[64:79]
    ds_read_b128 v[128:131], v13 offset:45056
    ds_read_b64_tr_b16 v[132:133], v12 offset:20480
    ds_read_b64_tr_b16 v[134:135], v12 offset:21504
    s_waitcnt lgkmcnt(9)
    v_mfma_f32_32x32x16_bf16 v[64:79], v[168:171], v[172:175], v[64:79]
    ds_read_b128 v[136:139], v13 offset:47104
    ds_read_b64_tr_b16 v[140:141], v12 offset:22528
    ds_read_b64_tr_b16 v[142:143], v12 offset:23552
    s_barrier
    s_waitcnt lgkmcnt(9)
    v_mfma_f32_32x32x16_bf16 v[64:79], v[112:115], v[116:119], v[64:79]
    ds_read_b128 v[144:147], v14 offset:49152
    ds_read_b64_tr_b16 v[148:149], v11 offset:24576
    ds_read_b64_tr_b16 v[150:151], v11 offset:25600
    s_waitcnt lgkmcnt(9)
    v_mfma_f32_32x32x16_bf16 v[64:79], v[120:123], v[124:127], v[64:79]
    ds_read_b128 v[152:155], v14 offset:51200
    ds_read_b64_tr_b16 v[156:157], v11 offset:26624
    ds_read_b64_tr_b16 v[158:159], v11 offset:27648
    s_waitcnt lgkmcnt(9)
    v_mfma_f32_32x32x16_bf16 v[64:79], v[128:131], v[132:135], v[64:79]
    ds_read_b128 v[160:163], v14 offset:53248
    ds_read_b64_tr_b16 v[164:165], v11 offset:28672
    ds_read_b64_tr_b16 v[166:167], v11 offset:29696
    s_waitcnt lgkmcnt(9)
    v_mfma_f32_32x32x16_bf16 v[64:79], v[136:139], v[140:143], v[64:79]
    ds_read_b128 v[168:171], v14 offset:55296
    ds_read_b64_tr_b16 v[172:173], v11 offset:30720
    ds_read_b64_tr_b16 v[174:175], v11 offset:31744
    s_barrier
    s_waitcnt lgkmcnt(9)
    v_mfma_f32_32x32x16_bf16 v[64:79], v[144:147], v[148:151], v[64:79]
    ds_read_b128 v[112:115], v13 offset:49152
    ds_read_b64_tr_b16 v[116:117], v10 offset:8192
    ds_read_b64_tr_b16 v[118:119], v10 offset:9216
    s_waitcnt lgkmcnt(9)
    v_mfma_f32_32x32x16_bf16 v[64:79], v[152:155], v[156:159], v[64:79]
    ds_read_b128 v[120:123], v13 offset:51200
    ds_read_b64_tr_b16 v[124:125], v10 offset:10240
    ds_read_b64_tr_b16 v[126:127], v10 offset:11264
    s_waitcnt lgkmcnt(9)
    v_mfma_f32_32x32x16_bf16 v[64:79], v[160:163], v[164:167], v[64:79]
    ds_read_b128 v[128:131], v13 offset:53248
    ds_read_b64_tr_b16 v[132:133], v10 offset:12288
    ds_read_b64_tr_b16 v[134:135], v10 offset:13312
    s_waitcnt lgkmcnt(9)
    v_mfma_f32_32x32x16_bf16 v[64:79], v[168:171], v[172:175], v[64:79]
    ds_read_b128 v[136:139], v13 offset:55296
    ds_read_b64_tr_b16 v[140:141], v10 offset:14336
    ds_read_b64_tr_b16 v[142:143], v10 offset:15360
    s_barrier
    s_waitcnt lgkmcnt(9)
    v_mfma_f32_32x32x16_bf16 v[64:79], v[112:115], v[116:119], v[64:79]
    ds_read_b128 v[144:147], v14 offset:57344
    ds_read_b64_tr_b16 v[148:149], v11 offset:32768
    ds_read_b64_tr_b16 v[150:151], v11 offset:33792
    s_waitcnt lgkmcnt(9)
    v_mfma_f32_32x32x16_bf16 v[64:79], v[120:123], v[124:127], v[64:79]
    ds_read_b128 v[152:155], v14 offset:59392
    ds_read_b64_tr_b16 v[156:157], v11 offset:34816
    ds_read_b64_tr_b16 v[158:159], v11 offset:35840
    s_waitcnt lgkmcnt(9)
    v_mfma_f32_32x32x16_bf16 v[64:79], v[128:131], v[132:135], v[64:79]
    ds_read_b128 v[160:163], v14 offset:61440
    ds_read_b64_tr_b16 v[164:165], v11 offset:36864
    ds_read_b64_tr_b16 v[166:167], v11 offset:37888
    s_waitcnt lgkmcnt(9)
    v_mfma_f32_32x32x16_bf16 v[64:79], v[136:139], v[140:143], v[64:79]
    ds_read_b128 v[168:171], v14 offset:63488
    ds_read_b64_tr_b16 v[172:173], v11 offset:38912
    ds_read_b64_tr_b16 v[174:175], v11 offset:39936
    s_waitcnt lgkmcnt(9)
    v_mfma_f32_32x32x16_bf16 v[64:79], v[144:147], v[148:151], v[64:79]
    s_waitcnt lgkmcnt(6)
    v_mfma_f32_32x32x16_bf16 v[64:79], v[152:155], v[156:159], v[64:79]
    s_waitcnt lgkmcnt(3)
    v_mfma_f32_32x32x16_bf16 v[64:79], v[160:163], v[164:167], v[64:79]
    s_waitcnt lgkmcnt(0)
    v_mfma_f32_32x32x16_bf16 v[64:79], v[168:171], v[172:175], v[64:79]
    s_nop 11
    v_pk_mul_f32 v[96:97], v[64:65], s[64:65] op_sel_hi:[1,0]
    v_pk_mul_f32 v[98:99], v[66:67], s[64:65] op_sel_hi:[1,0]
    v_pk_mul_f32 v[100:101], v[68:69], s[64:65] op_sel_hi:[1,0]
    v_pk_mul_f32 v[102:103], v[70:71], s[64:65] op_sel_hi:[1,0]
    v_exp_f32 v96, v96
    v_exp_f32 v97, v97
    v_exp_f32 v98, v98
    v_exp_f32 v99, v99
    v_exp_f32 v100, v100
    v_exp_f32 v101, v101
    v_exp_f32 v102, v102
    v_exp_f32 v103, v103
    v_pk_add_f32 v[96:97], v[96:97], 1.0 op_sel_hi:[1,0]
    v_pk_add_f32 v[98:99], v[98:99], 1.0 op_sel_hi:[1,0]
    v_pk_add_f32 v[100:101], v[100:101], 1.0 op_sel_hi:[1,0]
    v_pk_add_f32 v[102:103], v[102:103], 1.0 op_sel_hi:[1,0]
    v_rcp_f32 v96, v96
    v_rcp_f32 v97, v97
    v_rcp_f32 v98, v98
    v_rcp_f32 v99, v99
    v_rcp_f32 v100, v100
    v_rcp_f32 v101, v101
    v_rcp_f32 v102, v102
    v_rcp_f32 v103, v103
    v_pk_mul_f32 v[64:65], v[64:65], v[48:49]
    v_pk_mul_f32 v[66:67], v[66:67], v[50:51]
    v_pk_mul_f32 v[68:69], v[68:69], v[52:53]
    v_pk_mul_f32 v[70:71], v[70:71], v[54:55]
    v_pk_fma_f32 v[80:81], v[64:65], v[96:97], v[80:81]
    v_pk_fma_f32 v[82:83], v[66:67], v[98:99], v[82:83]
    v_pk_fma_f32 v[84:85], v[68:69], v[100:101], v[84:85]
    v_pk_fma_f32 v[86:87], v[70:71], v[102:103], v[86:87]
    v_cvt_pk_bf16_f32 v176, v80, v81
    v_cvt_pk_bf16_f32 v177, v82, v83
    v_cvt_pk_bf16_f32 v178, v84, v85
    v_cvt_pk_bf16_f32 v179, v86, v87
    s_nop 0
    v_permlane32_swap_b32 v176, v178
    v_permlane32_swap_b32 v177, v179
    v_pk_mul_f32 v[96:97], v[72:73], s[64:65] op_sel_hi:[1,0]
    v_pk_mul_f32 v[98:99], v[74:75], s[64:65] op_sel_hi:[1,0]
    v_pk_mul_f32 v[100:101], v[76:77], s[64:65] op_sel_hi:[1,0]
    v_pk_mul_f32 v[102:103], v[78:79], s[64:65] op_sel_hi:[1,0]
    v_exp_f32 v96, v96
    v_exp_f32 v97, v97
    v_exp_f32 v98, v98
    v_exp_f32 v99, v99
    v_exp_f32 v100, v100
    v_exp_f32 v101, v101
    v_exp_f32 v102, v102
    v_exp_f32 v103, v103
    v_pk_add_f32 v[96:97], v[96:97], 1.0 op_sel_hi:[1,0]
    v_pk_add_f32 v[98:99], v[98:99], 1.0 op_sel_hi:[1,0]
    v_pk_add_f32 v[100:101], v[100:101], 1.0 op_sel_hi:[1,0]
    v_pk_add_f32 v[102:103], v[102:103], 1.0 op_sel_hi:[1,0]
    v_rcp_f32 v96, v96
    v_rcp_f32 v97, v97
    v_rcp_f32 v98, v98
    v_rcp_f32 v99, v99
    v_rcp_f32 v100, v100
    v_rcp_f32 v101, v101
    v_rcp_f32 v102, v102
    v_rcp_f32 v103, v103
    v_pk_mul_f32 v[72:73], v[72:73], v[56:57]
    v_pk_mul_f32 v[74:75], v[74:75], v[58:59]
    v_pk_mul_f32 v[76:77], v[76:77], v[60:61]
    v_pk_mul_f32 v[78:79], v[78:79], v[62:63]
    v_pk_fma_f32 v[88:89], v[72:73], v[96:97], v[88:89]
    v_pk_fma_f32 v[90:91], v[74:75], v[98:99], v[90:91]
    v_pk_fma_f32 v[92:93], v[76:77], v[100:101], v[92:93]
    v_pk_fma_f32 v[94:95], v[78:79], v[102:103], v[94:95]
    v_cvt_pk_bf16_f32 v180, v88, v89
    v_cvt_pk_bf16_f32 v181, v90, v91
    v_cvt_pk_bf16_f32 v182, v92, v93
    v_cvt_pk_bf16_f32 v183, v94, v95
    s_nop 0
    v_permlane32_swap_b32 v180, v182
    v_permlane32_swap_b32 v181, v183
    s_nop 0
    v_permlane16_swap_b32 v176, v180
    v_permlane16_swap_b32 v177, v181
    v_permlane16_swap_b32 v178, v182
    v_permlane16_swap_b32 v179, v183
    buffer_store_dwordx4 v[176:179], v40, s[12:15], s62 offen sc1
    buffer_store_dwordx4 v[180:183], v41, s[12:15], s62 offen sc1
    s_endpgm
L_chelper:
    s_mov_b32 s60, 0x35c1a2a0
    s_mov_b32 s61, 0x3f317218
    v_pk_fma_f32 v[48:49], v[176:177], v[96:97], v[48:49] op_sel_hi:[0,1,1] neg_lo:[1,0,0] neg_hi:[1,0,0]
    v_pk_fma_f32 v[50:51], v[176:177], v[98:99], v[50:51] op_sel_hi:[0,1,1] neg_lo:[1,0,0] neg_hi:[1,0,0]
    v_pk_fma_f32 v[48:49], v[48:49], v[176:177], s[60:61] op_sel:[0,1,0] op_sel_hi:[1,1,0]
    v_pk_fma_f32 v[50:51], v[50:51], v[176:177], s[60:61] op_sel:[0,1,0] op_sel_hi:[1,1,0]
    v_exp_f32_e64 v128, v48 clamp
    v_exp_f32_e64 v129, v49 clamp
    v_exp_f32_e64 v130, v50 clamp
    v_exp_f32_e64 v131, v51 clamp
    v_max_f32 v48, s60, v48
    v_max_f32 v49, s60, v49
    v_max_f32 v50, s60, v50
    v_max_f32 v51, s60, v51
    v_pk_fma_f32 v[48:49], v[48:49], s[60:61], v[128:129] op_sel:[0,1,0] op_sel_hi:[1,1,1]
    v_pk_fma_f32 v[50:51], v[50:51], s[60:61], v[130:131] op_sel:[0,1,0] op_sel_hi:[1,1,1]
    v_cvt_pk_bf16_f32 v28, v48, v49
    v_cvt_pk_bf16_f32 v29, v50, v51
    v_pk_fma_f32 v[52:53], v[178:179], v[96:97], v[52:53] op_sel_hi:[0,1,1] neg_lo:[1,0,0] neg_hi:[1,0,0]
    v_pk_fma_f32 v[54:55], v[178:179], v[98:99], v[54:55] op_sel_hi:[0,1,1] neg_lo:[1,0,0] neg_hi:[1,0,0]
    v_pk_fma_f32 v[52:53], v[52:53], v[178:179], s[60:61] op_sel:[0,1,0] op_sel_hi:[1,1,0]
    v_pk_fma_f32 v[54:55], v[54:55], v[178:179], s[60:61] op_sel:[0,1,0] op_sel_hi:[1,1,0]
    v_exp_f32_e64 v128, v52 clamp
    v_exp_f32_e64 v129, v53 clamp
    v_exp_f32_e64 v130, v54 clamp
    v_exp_f32_e64 v131, v55 clamp
    v_max_f32 v52, s60, v52
    v_max_f32 v53, s60, v53
    v_max_f32 v54, s60, v54
    v_max_f32 v55, s60, v55
    v_pk_fma_f32 v[52:53], v[52:53], s[60:61], v[128:129] op_sel:[0,1,0] op_sel_hi:[1,1,1]
    v_pk_fma_f32 v[54:55], v[54:55], s[60:61], v[130:131] op_sel:[0,1,0] op_sel_hi:[1,1,1]
    v_cvt_pk_bf16_f32 v30, v52, v53
    v_cvt_pk_bf16_f32 v31, v54, v55
    v_pk_fma_f32 v[56:57], v[180:181], v[96:97], v[56:57] op_sel_hi:[0,1,1] neg_lo:[1,0,0] neg_hi:[1,0,0]
    v_pk_fma_f32 v[58:59], v[180:181], v[98:99], v[58:59] op_sel_hi:[0,1,1] neg_lo:[1,0,0] neg_hi:[1,0,0]
    v_pk_fma_f32 v[56:57], v[56:57], v[180:181], s[60:61] op_sel:[0,1,0] op_sel_hi:[1,1,0]
    v_pk_fma_f32 v[58:59], v[58:59], v[180:181], s[60:61] op_sel:[0,1,0] op_sel_hi:[1,1,0]
    v_exp_f32_e64 v128, v56 clamp
    v_exp_f32_e64 v129, v57 clamp
    v_exp_f32_e64 v130, v58 clamp
    v_exp_f32_e64 v131, v59 clamp
    v_max_f32 v56, s60, v56
    v_max_f32 v57, s60, v57
    v_max_f32 v58, s60, v58
    v_max_f32 v59, s60, v59
    v_pk_fma_f32 v[56:57], v[56:57], s[60:61], v[128:129] op_sel:[0,1,0] op_sel_hi:[1,1,1]
    v_pk_fma_f32 v[58:59], v[58:59], s[60:61], v[130:131] op_sel:[0,1,0] op_sel_hi:[1,1,1]
    v_cvt_pk_bf16_f32 v32, v56, v57
    v_cvt_pk_bf16_f32 v33, v58, v59
    v_pk_fma_f32 v[60:61], v[182:183], v[96:97], v[60:61] op_sel_hi:[0,1,1] neg_lo:[1,0,0] neg_hi:[1,0,0]
    v_pk_fma_f32 v[62:63], v[182:183], v[98:99], v[62:63] op_sel_hi:[0,1,1] neg_lo:[1,0,0] neg_hi:[1,0,0]
    v_pk_fma_f32 v[60:61], v[60:61], v[182:183], s[60:61] op_sel:[0,1,0] op_sel_hi:[1,1,0]
    v_pk_fma_f32 v[62:63], v[62:63], v[182:183], s[60:61] op_sel:[0,1,0] op_sel_hi:[1,1,0]
    v_exp_f32_e64 v128, v60 clamp
    v_exp_f32_e64 v129, v61 clamp
    v_exp_f32_e64 v130, v62 clamp
    v_exp_f32_e64 v131, v63 clamp
    v_max_f32 v60, s60, v60
    v_max_f32 v61, s60, v61
    v_max_f32 v62, s60, v62
    v_max_f32 v63, s60, v63
    v_pk_fma_f32 v[60:61], v[60:61], s[60:61], v[128:129] op_sel:[0,1,0] op_sel_hi:[1,1,1]
    v_pk_fma_f32 v[62:63], v[62:63], s[60:61], v[130:131] op_sel:[0,1,0] op_sel_hi:[1,1,1]
    v_cvt_pk_bf16_f32 v34, v60, v61
    v_cvt_pk_bf16_f32 v35, v62, v63
    s_lshr_b32 s60, s2, 3
    s_cmp_lt_u32 s60, 24
    s_cbranch_scc1 L_nored
    s_lshl_b32 s60, s33, 3
    s_add_u32 s60, s60, s52
    s_lshl_b32 s60, s60, 2
    s_add_u32 s60, s60, s3
    s_lshl_b32 s62, s60, 12
    s_add_u32 s62, s62, 1048576
    s_lshl_b32 s66, s60, 7
    s_add_u32 s66, s66, 524288
    s_lshr_b32 s67, s60, 3
    s_lshl_b32 s67, s67, 8
    s_add_u32 s67, s67, 180224
    s_lshr_b32 s63, s60, 5
    s_lshl_b32 s63, s63, 11
    s_add_u32 s63, s63, 131072
    s_mov_b32 s68, 0
    s_atomic_add s68, s[58:59], s67 glc
    s_mov_b32 s74, 0
L_chk_K1:
    s_waitcnt lgkmcnt(0)
    s_sub_u32 s68, s68, s32
    s_cmp_eq_u32 s68, 32
    s_cbranch_scc1 L_ok_K1
    s_add_u32 s74, s74, 1
    s_cmp_gt_u32 s74, 40000
    s_cbranch_scc1 L_ok_K1
    s_sleep 1
    s_mov_b32 s68, 0
    s_atomic_add s68, s[58:59], s67 glc
    s_branch L_chk_K1
L_ok_K1:
    s_mov_b32 s74, 0
L_red:
    buffer_load_dwordx4 v[144:147], v46, s[4:7], s62 offen offset:0 sc1
    buffer_load_dwordx4 v[148:151], v46, s[4:7], s62 offen offset:1024 sc1
    buffer_load_dwordx4 v[152:155], v46, s[4:7], s62 offen offset:2048 sc1
    buffer_load_dwordx4 v[156:159], v46, s[4:7], s62 offen offset:3072 sc1
    s_waitcnt vmcnt(0)
    v_xor_b32 v147, s32, v147
    v_xor_b32 v151, s32, v151
    v_xor_b32 v155, s32, v155
    v_xor_b32 v159, s32, v159
    v_or3_b32 v147, v147, v151, v155
    v_or_b32 v147, v147, v159
    v_cmp_ne_u32 vcc, 0, v147
    s_cbranch_vccz L_redok
    s_sleep 8
    s_add_u32 s74, s74, 1
    s_cmp_le_u32 s74, 20000
    s_cbranch_scc1 L_red
L_redok:
    v_lshlrev_b32 v160, 16, v144
    v_and_b32 v161, 0xffff0000, v144
    v_lshlrev_b32 v162, 16, v145
    v_and_b32 v163, 0xffff0000, v145
    v_lshlrev_b32 v168, 16, v148
    v_and_b32 v169, 0xffff0000, v148
    v_lshlrev_b32 v170, 16, v149
    v_and_b32 v171, 0xffff0000, v149
    v_pk_add_f32 v[160:161], v[160:161], v[168:169]
    v_pk_add_f32 v[162:163], v[162:163], v[170:171]
    v_lshlrev_b32 v168, 16, v152
    v_and_b32 v169, 0xffff0000, v152
    v_lshlrev_b32 v170, 16, v153
    v_and_b32 v171, 0xffff0000, v153
    v_pk_add_f32 v[160:161], v[160:161], v[168:169]
    v_pk_add_f32 v[162:163], v[162:163], v[170:171]
    v_lshlrev_b32 v168, 16, v156
    v_and_b32 v169, 0xffff0000, v156
    v_lshlrev_b32 v170, 16, v157
    v_and_b32 v171, 0xffff0000, v157
    v_pk_add_f32 v[160:161], v[160:161], v[168:169]
    v_pk_add_f32 v[162:163], v[162:163], v[170:171]
    v_add_f32 v164, v146, v150
    v_add_f32 v168, v154, v158
    v_add_f32 v164, v164, v168
    v_add_f32_dpp v160, v160, v160 row_ror:8 row_mask:0xf bank_mask:0xf
    v_add_f32_dpp v161, v161, v161 row_ror:8 row_mask:0xf bank_mask:0xf
    v_add_f32_dpp v162, v162, v162 row_ror:8 row_mask:0xf bank_mask:0xf
    v_add_f32_dpp v163, v163, v163 row_ror:8 row_mask:0xf bank_mask:0xf
    v_add_f32_dpp v164, v164, v164 row_ror:8 row_mask:0xf bank_mask:0xf
    v_mov_b32 v168, v160
    v_mov_b32 v169, v161
    v_mov_b32 v170, v162
    v_mov_b32 v171, v163
    v_mov_b32 v172, v164
    v_permlane16_swap_b32 v160, v168
    v_permlane16_swap_b32 v161, v169
    v_permlane16_swap_b32 v162, v170
    v_permlane16_swap_b32 v163, v171
    v_permlane16_swap_b32 v164, v172
    v_add_f32 v160, v160, v168
    v_add_f32 v161, v161, v169
    v_add_f32 v162, v162, v170
    v_add_f32 v163, v163, v171
    v_add_f32 v164, v164, v172
    v_mov_b32 v168, v160
    v_mov_b32 v169, v161
    v_mov_b32 v170, v162
    v_mov_b32 v171, v163
    v_mov_b32 v172, v164
    v_permlane32_swap_b32 v160, v168
    v_permlane32_swap_b32 v161, v169
    v_permlane32_swap_b32 v162, v170
    v_permlane32_swap_b32 v163, v171
    v_permlane32_swap_b32 v164, v172
    v_add_f32 v160, v160, v168
    v_add_f32 v161, v161, v169
    v_add_f32 v162, v162, v170
    v_add_f32 v163, v163, v171
    v_add_f32 v164, v164, v172
    v_cvt_pk_bf16_f32 v160, v160, v161
    v_cvt_pk_bf16_f32 v161, v162, v163
    v_mov_b32 v162, v164
    v_mov_b32 v163, s32
    v_lshlrev_b32 v36, 8, v1
    v_mov_b32 v37, 1
    s_mov_b64 exec, 255
    buffer_store_dwordx4 v[160:163], v46, s[4:7], s66 offen sc1
    buffer_atomic_add v37, v36, s[4:7], s63 offen
    s_mov_b64 exec, -1
L_nored:
    s_lshl_b32 s67, s35, 3
    s_and_b32 s61, s33, 6
    s_add_u32 s67, s67, s61
    s_add_u32 s67, s67, s71
    s_lshl_b32 s67, s67, 8
    s_add_u32 s67, s67, 131072
    s_mov_b32 s68, 0
    s_atomic_add s68, s[58:59], s67 glc
    s_mov_b32 s74, 0
L_chk_K2h:
    s_waitcnt lgkmcnt(0)
    s_sub_u32 s68, s68, s32
    s_cmp_eq_u32 s68, 32
    s_cbranch_scc1 L_ok_K2h
    s_add_u32 s74, s74, 1
    s_cmp_gt_u32 s74, 40000
    s_cbranch_scc1 L_ok_K2h
    s_sleep 4
    s_mov_b32 s68, 0
    s_atomic_add s68, s[58:59], s67 glc
    s_branch L_chk_K2h
L_ok_K2h:
    buffer_load_dwordx4 v[120:123], v46, s[4:7], s70 offen sc1
    v_and_b32 v36, 1, v3
    v_lshlrev_b32 v36, 5, v36
    v_lshl_add_u32 v36, v43, 4, v36
    v_add_lshl_u32 v36, v36, v2, 4
    s_lshl_b32 s60, s34, 16
    s_lshl_b32 s61, s35, 13
    s_add_u32 s60, s60, s61
    s_lshl_b32 s61, s3, 11
    s_add_u32 s60, s60, s61
    s_add_u32 s60, s60, 4194304
    s_mov_b32 s74, 0
    s_waitcnt vmcnt(0)
L_kvchkh:
    v_cmp_ne_u32 vcc, s32, v123
    s_cbranch_vccz L_kvokh
    s_add_u32 s74, s74, 1
    s_cmp_gt_u32 s74, 20000
    s_cbranch_scc1 L_kvokh
    s_sleep 8
    buffer_load_dwordx4 v[120:123], v46, s[4:7], s70 offen sc1
    s_waitcnt vmcnt(0)
    s_branch L_kvchkh
L_kvokh:
    v_mov_b32_dpp v160, v122 quad_perm:[0,0,0,0] row_mask:0xf bank_mask:0xf
    v_mov_b32_dpp v161, v122 quad_perm:[1,1,1,1] row_mask:0xf bank_mask:0xf
    v_mov_b32_dpp v162, v122 quad_perm:[2,2,2,2] row_mask:0xf bank_mask:0xf
    v_mov_b32_dpp v163, v122 quad_perm:[3,3,3,3] row_mask:0xf bank_mask:0xf
    v_cvt_pk_bf16_f32 v122, v160, v161
    v_cvt_pk_bf16_f32 v123, v162, v163
    s_nop 1
    v_mfma_f32_16x16x16_bf16 v[160:163], v[122:123], v[28:29], 0
    v_mfma_f32_16x16x16_bf16 v[164:167], v[122:123], v[30:31], 0
    v_mfma_f32_16x16x16_bf16 v[168:171], v[122:123], v[32:33], 0
    v_mfma_f32_16x16x16_bf16 v[172:175], v[122:123], v[34:35], 0
    v_mfma_f32_16x16x16_bf16 v[144:147], v[120:121], v[28:29], 0
    v_mfma_f32_16x16x16_bf16 v[148:151], v[120:121], v[30:31], 0
    v_mfma_f32_16x16x16_bf16 v[152:155], v[120:121], v[32:33], 0
    v_mfma_f32_16x16x16_bf16 v[156:159], v[120:121], v[34:35], 0
    s_nop 0
    v_add_f32 v160, 0x358637bd, v160
    v_add_f32 v164, 0x358637bd, v164
    v_add_f32 v168, 0x358637bd, v168
    v_add_f32 v172, 0x358637bd, v172
    v_rcp_f32 v160, v160
    v_rcp_f32 v164, v164
    v_rcp_f32 v168, v168
    v_rcp_f32 v172, v172
    v_pk_mul_f32 v[144:145], v[144:145], v[160:161] op_sel_hi:[1,0]
    v_pk_mul_f32 v[146:147], v[146:147], v[160:161] op_sel_hi:[1,0]
    v_cvt_pk_bf16_f32 v112, v144, v145
    v_cvt_pk_bf16_f32 v113, v146, v147
    v_pk_mul_f32 v[148:149], v[148:149], v[164:165] op_sel_hi:[1,0]
    v_pk_mul_f32 v[150:151], v[150:151], v[164:165] op_sel_hi:[1,0]
    v_cvt_pk_bf16_f32 v114, v148, v149
    v_cvt_pk_bf16_f32 v115, v150, v151
    v_pk_mul_f32 v[152:153], v[152:153], v[168:169] op_sel_hi:[1,0]
    v_pk_mul_f32 v[154:155], v[154:155], v[168:169] op_sel_hi:[1,0]
    v_cvt_pk_bf16_f32 v116, v152, v153
    v_cvt_pk_bf16_f32 v117, v154, v155
    v_pk_mul_f32 v[156:157], v[156:157], v[172:173] op_sel_hi:[1,0]
    v_pk_mul_f32 v[158:159], v[158:159], v[172:173] op_sel_hi:[1,0]
    v_cvt_pk_bf16_f32 v118, v156, v157
    v_cvt_pk_bf16_f32 v119, v158, v159
    v_permlane32_swap_b32 v112, v114
    v_permlane32_swap_b32 v113, v115
    buffer_store_dwordx4 v[112:115], v36, s[4:7], s60 offen offset:0 sc1
    v_permlane32_swap_b32 v116, v118
    v_permlane32_swap_b32 v117, v119
    buffer_store_dwordx4 v[116:119], v36, s[4:7], s60 offen offset:1024 sc1
    s_lshl_b32 s60, s34, 9
    s_add_u32 s60, s60, 147456
    v_lshlrev_b32 v39, 8, v1
    v_mov_b32 v37, 1
    s_waitcnt vmcnt(0)
    s_mov_b64 exec, 3
    buffer_atomic_add v37, v39, s[4:7], s60 offen
    s_mov_b64 exec, -1
    s_barrier
    s_barrier
    s_branch L_cjoin
L_end:
.section .rodata,"a"
.p2align 6
.amdhsa_kernel recurrent_scan__linear_attn_block__mixer_token_mlp__prompt_kernel
.amdhsa_next_free_vgpr 256
.amdhsa_next_free_sgpr 100
.amdhsa_accum_offset 256
.amdhsa_group_segment_fixed_size 0
.amdhsa_kernarg_size 88
.amdhsa_user_sgpr_count 2
.amdhsa_user_sgpr_kernarg_segment_ptr 1
.amdhsa_system_sgpr_workgroup_id_x 1
.end_amdhsa_kernel
```
